```python
import torch

def _softmax(x, axis=-1):
    return torch.softmax(x, dim=axis)
def _gelu(x):
    return torch.nn.functional.gelu(x, approximate="tanh")
def _silu(x):
    return torch.nn.functional.silu(x)
def _sigmoid(x):
    return torch.sigmoid(x)
def _layernorm(x, axis=-1, eps=1e-5):
    m = x.mean(dim=axis, keepdim=True)
    v = x.var(dim=axis, keepdim=True, unbiased=False)
    return (x - m) / torch.sqrt(v + eps)
def _scatter_add(tgt, idx, src, axis=0):
    return tgt.clone().index_add_(axis, idx, src)
def _segment_sum(src, seg, n):
    out = torch.zeros((n,) + src.shape[1:], dtype=src.dtype)
    return out.index_add_(0, seg, src)
def _pad(x, pw):
    flat = tuple(v for pair in reversed(pw) for v in pair)
    return torch.nn.functional.pad(x, flat)

kernel_name = 'standalone__seq2seq_rnn_t_joint__speech'

def setup_inputs():

    _w = (lambda a: (lambda t: t.to(torch.bfloat16) if t.is_floating_point() else t)(torch.as_tensor(a)))
    B, T, D, K = 2, 1000, 512, 3
    U = 8
    sc = (1.0 / (K * D)) ** 0.5
    sd = (1.0 / D) ** 0.5
    return {
        "x": _w((lambda *s: torch.randn(*s, dtype=torch.bfloat16) * 0.4)(B, T, D) * 0.5),
        "w1": _w((lambda *s: torch.randn(*s, dtype=torch.bfloat16) * 3.2)(K, D, D) * sc),
        "w2": _w((lambda *s: torch.randn(*s, dtype=torch.bfloat16) * 3.2)(K, D, D) * sc),
        "g": _w((lambda *s: torch.randn(*s, dtype=torch.bfloat16) * 3.2)(B, U, D) * 0.5),
        "w_f": _w((lambda *s: torch.randn(*s, dtype=torch.bfloat16) * 3.2)(D, D) * sd),
        "w_g": _w((lambda *s: torch.randn(*s, dtype=torch.bfloat16) * 3.2)(D, D) * sd),
        "w_o": _w((lambda *s: torch.randn(*s, dtype=torch.bfloat16) * 3.2)(D, D) * sd),
    }

def reference(x, w1, w2, g, w_f, w_g, w_o):
    B, T, D = x.shape
    K = w1.shape[0]
    pad = K // 2
    xp = _pad(x, ((0,0),(pad,pad),(0,0)))
    h = torch.zeros_like(x)
    for i in range(K):
        h = h + torch.einsum("btc,cd->btd", xp[:, i:i+T, :], w1[i])
    h = _gelu(h)[:, ::2, :]
    T1 = h.shape[1]
    hp = _pad(h, ((0,0),(pad,pad),(0,0)))
    f = torch.zeros_like(h)
    for i in range(K):
        f = f + torch.einsum("btc,cd->btd", hp[:, i:i+T1, :], w2[i])
    f = _gelu(f)[:, ::2, :]
    fe = torch.einsum("btd,de->bte", f, w_f)
    ge = torch.einsum("bud,de->bue", g, w_g)
    j = torch.tanh(fe[:, :, None, :] + ge[:, None, :, :])
    return torch.einsum("btud,dv->btuv", j, w_o)
```

```asm
; @launch grid=(256,1,1) block=(256,1,1) lds=163840
.amdgcn_target "amdgcn-amd-amdhsa--gfx950"
.text
.globl standalone__seq2seq_rnn_t_joint__speech_kernel
.p2align 8
.type standalone__seq2seq_rnn_t_joint__speech_kernel,@function
standalone__seq2seq_rnn_t_joint__speech_kernel:
    s_cmp_ge_u32 s2, 256
    s_cbranch_scc1 Lexit
    s_load_dwordx16 s[64:79], s[0:1], 0
    s_load_dwordx4 s[80:83], s[0:1], 64
    s_getpc_b64 s[40:41]
    v_lshrrev_b32 v1, 6, v0
    v_and_b32 v0, 63, v0
    v_readfirstlane_b32 s44, v1
    s_and_b32 s45, s2, 7
    s_lshr_b32 s46, s2, 3
    s_lshr_b32 s47, s45, 2
    s_bfe_u32 s48, s45, 0x10001
    s_lshl_b32 s48, s48, 3
    s_lshr_b32 s55, s46, 2
    s_add_u32 s48, s48, s55
    s_and_b32 s49, s45, 1
    s_lshl_b32 s49, s49, 2
    s_and_b32 s57, s46, 3
    s_add_u32 s49, s49, s57
    s_mul_i32 s54, s44, 40960
    s_lshl_b32 s87, s57, 14
    s_mov_b32 s86, 1073741824
    s_and_b32 s40, s40, 0xffffff00
    s_mov_b32 s42, Lcode_end-standalone__seq2seq_rnn_t_joint__speech_kernel
    s_mov_b32 s43, 0x00020000
    s_lshl_b32 s58, s46, 3
    s_lshl_b32 s59, s44, 1
    s_add_u32 s58, s58, s59
    v_add_u32 v2, s58, v0
    v_lshlrev_b32 v2, 7, v2
    v_mov_b32 v3, s86
    v_cmp_gt_u32 vcc, 2, v0
    s_nop 1
    v_cndmask_b32 v2, v3, v2, vcc
    v_lshrrev_b32 v6, 4, v0
    v_and_b32 v7, 15, v0
    v_lshlrev_b32 v7, 4, v7
    s_lshl_b32 s58, s44, 8
    v_add_u32 v7, s58, v7
    v_lshl_add_u32 v4, v6, 10, v7
    v_add_u32 v4, 1024, v4
    s_cmp_lg_u32 s48, 0
    s_cselect_b32 s59, 48, 64
    v_cmp_le_u32 vcc, s59, v0
    s_nop 1
    v_cndmask_b32 v5, v3, v7, vcc
    v_lshrrev_b32 v6, 2, v0
    v_and_b32 v6, 4, v6
    v_and_b32 v8, 7, v0
    v_xor_b32 v8, v8, v6
    v_lshlrev_b32 v8, 4, v8
    v_lshrrev_b32 v6, 3, v0
    v_lshl_add_u32 v8, v6, 10, v8
    s_lshl_b32 s58, s44, 17
    v_add_u32 v8, s58, v8
    v_add_u32 v9, 7168, v8
    v_mov_b32 v10, 0
    s_mul_i32 s60, s47, 1024000
    s_lshl_b32 s61, s48, 16
    s_add_u32 s60, s60, s61
    s_sub_u32 s6, 1025024, s61
    s_mov_b32 s7, 0x00020000
    s_lshl_b32 s62, s49, 7
    s_sub_u32 s10, 1572864, s62
    s_mov_b32 s11, 0x00020000
    s_mov_b32 s26, 5505024
    s_mov_b32 s27, 0x00020000
    s_lshl_b32 s63, s55, 14
    buffer_load_dword v11, v2, s[40:43], 0 offen
    s_waitcnt lgkmcnt(0)
    s_add_u32 s4, s64, s60
    s_addc_u32 s5, s65, 0
    s_sub_u32 s4, s4, 1024
    s_subb_u32 s5, s5, 0
    s_mov_b32 m0, s54
    s_add_u32 s8, s66, s62
    buffer_load_dwordx4 v5, s[4:7], 0 offen lds
    s_addc_u32 s9, s67, 0
    s_add_u32 s93, s54, 1024
    s_add_u32 s88, s87, 4096
    s_and_b32 s88, s88, 0xffff
    s_lshr_b32 s57, s88, 8
    v_xor_b32 v6, s57, v4
    s_lshr_b32 s58, s87, 2
    s_add_u32 m0, s93, s58
    s_nop 0
    buffer_load_dwordx4 v6, s[4:7], s87 offen lds
    s_add_u32 s87, s88, 4096
    s_and_b32 s87, s87, 0xffff
    s_lshr_b32 s57, s87, 8
    v_xor_b32 v7, s57, v4
    s_lshr_b32 s58, s88, 2
    s_add_u32 m0, s93, s58
    s_nop 0
    buffer_load_dwordx4 v7, s[4:7], s88 offen lds
    s_add_u32 s88, s87, 4096
    s_and_b32 s88, s88, 0xffff
    s_lshr_b32 s57, s88, 8
    v_xor_b32 v6, s57, v4
    s_lshr_b32 s58, s87, 2
    s_add_u32 m0, s93, s58
    s_nop 0
    buffer_load_dwordx4 v6, s[4:7], s87 offen lds
    s_add_u32 s87, s88, 4096
    s_and_b32 s87, s87, 0xffff
    s_lshr_b32 s57, s87, 8
    v_xor_b32 v7, s57, v4
    s_lshr_b32 s58, s88, 2
    s_add_u32 m0, s93, s58
    s_nop 0
    buffer_load_dwordx4 v7, s[4:7], s88 offen lds
    s_mov_b32 s24, s82
    s_mov_b32 s25, s83
    s_add_u32 m0, s54, 18432
    s_nop 0
    buffer_load_dwordx4 v8, s[8:11], s63 offen lds
    buffer_load_dwordx4 v9, s[8:11], s63 offen offset:1024 lds
    s_add_u32 m0, s54, 20480
    s_add_u32 s57, s63, 524288
    buffer_load_dwordx4 v8, s[8:11], s57 offen lds
    buffer_load_dwordx4 v9, s[8:11], s57 offen offset:1024 lds
    s_add_u32 m0, s54, 22528
    s_add_u32 s57, s63, 1048576
    buffer_load_dwordx4 v8, s[8:11], s57 offen lds
    buffer_load_dwordx4 v9, s[8:11], s57 offen offset:1024 lds
    s_and_b32 s50, s45, 3
    s_lshl_b32 s50, s50, 1
    s_and_b32 s52, s46, 1
    s_add_u32 s50, s50, s52
    s_lshr_b32 s51, s46, 1
    s_and_b32 s53, s45, 3
    s_lshl_b32 s53, s53, 4
    s_add_u32 s53, s53, s51
    s_and_b32 s92, s51, 3
    s_lshl_b32 s58, s50, 7
    s_add_u32 s12, s68, s58
    s_addc_u32 s13, s69, 0
    s_mov_b32 s14, 0
    s_mov_b32 s15, 0x00020000
    s_sub_u32 s14, 1572864, s58
    s_lshl_b32 s58, s50, 16
    s_add_u32 s16, s72, s58
    s_addc_u32 s17, s73, 0
    s_mov_b32 s18, 65536
    s_mov_b32 s19, 0x00020000
    s_lshl_b32 s58, s52, 9
    s_add_u32 s20, s76, s58
    s_addc_u32 s21, s77, 0
    s_mov_b32 s22, 0
    s_mov_b32 s23, 0x00020000
    s_sub_u32 s22, 524288, s58
    s_mul_i32 s58, s47, 2048000
    s_add_u32 s28, s78, s58
    s_addc_u32 s29, s79, 0
    s_mov_b32 s30, 2048000
    s_mov_b32 s31, 0x00020000
    s_mov_b32 s32, s70
    s_mov_b32 s33, s71
    s_mov_b32 s34, 16384
    s_mov_b32 s35, 0x00020000
    s_mov_b32 s36, s74
    s_mov_b32 s37, s75
    s_mov_b32 s38, 524288
    s_mov_b32 s39, 0x00020000
    s_mov_b32 s84, 0xbdd2d3e8
    s_mov_b32 s85, 0x4038aa3b
    v_mov_b32 v252, 0xc0135761
    s_lshr_b32 s58, s46, 1
    v_mov_b32 v3, s86
    s_mul_i32 s59, s58, 96
    s_mul_i32 s60, s44, 24
    s_add_u32 s59, s59, s60
    v_add_u32 v1, s59, v0
    v_lshlrev_b32 v1, 10, v1
    v_cmp_gt_u32 vcc, 24, v0
    s_nop 1
    v_cndmask_b32 v247, v3, v1, vcc
    s_lshl_b32 s59, s58, 5
    s_lshl_b32 s60, s44, 3
    s_add_u32 s59, s59, s60
    v_add_u32 v1, s59, v0
    v_lshlrev_b32 v1, 7, v1
    v_cmp_gt_u32 vcc, 8, v0
    s_nop 1
    v_cndmask_b32 v248, v3, v1, vcc
    s_lshl_b32 s59, s58, 7
    s_lshl_b32 s60, s44, 5
    s_add_u32 s59, s59, s60
    v_add_u32 v1, s59, v0
    v_lshrrev_b32 v6, 2, v1
    v_lshlrev_b32 v6, 10, v6
    v_and_b32 v1, 3, v1
    v_lshl_add_u32 v1, v1, 7, v6
    v_cmp_gt_u32 vcc, 32, v0
    s_nop 1
    v_cndmask_b32 v249, v3, v1, vcc
    s_lshr_b32 s58, s46, 3
    s_and_b32 s61, s46, 7
    s_lshl_b32 s59, s58, 7
    s_lshl_b32 s60, s61, 4
    s_add_u32 s59, s59, s60
    s_lshl_b32 s60, s44, 2
    s_add_u32 s59, s59, s60
    v_add_u32 v1, s59, v0
    v_lshlrev_b32 v1, 10, v1
    s_lshl_b32 s60, s45, 7
    v_add_u32 v1, s60, v1
    v_cmp_gt_u32 vcc, 4, v0
    s_nop 1
    v_cndmask_b32 v250, v3, v1, vcc
    s_lshl_b32 s61, s61, 2
    s_add_u32 s61, s61, s44
    s_lshr_b32 s59, s61, 1
    s_lshl_b32 s59, s59, 10
    s_and_b32 s61, s61, 1
    s_lshl_b32 s61, s61, 7
    s_add_u32 s59, s59, s61
    s_lshl_b32 s58, s58, 8
    s_add_u32 s59, s59, s58
    v_mov_b32 v1, s59
    v_cmp_gt_u32 vcc, 1, v0
    s_nop 1
    v_cndmask_b32 v251, v3, v1, vcc
    buffer_load_dword v175, v250, s[36:39], 0 offen
    buffer_load_dword v176, v251, s[32:35], 0 offen
    s_add_u32 s88, s87, 4096
    s_and_b32 s88, s88, 0xffff
    s_lshr_b32 s57, s88, 8
    v_xor_b32 v6, s57, v4
    s_lshr_b32 s58, s87, 2
    s_add_u32 m0, s93, s58
    s_nop 0
    buffer_load_dwordx4 v6, s[4:7], s87 offen lds
    s_add_u32 s87, s88, 4096
    s_and_b32 s87, s87, 0xffff
    s_lshr_b32 s57, s87, 8
    v_xor_b32 v7, s57, v4
    s_lshr_b32 s58, s88, 2
    s_add_u32 m0, s93, s58
    s_nop 0
    buffer_load_dwordx4 v7, s[4:7], s88 offen lds
    s_add_u32 s88, s87, 4096
    s_and_b32 s88, s88, 0xffff
    s_lshr_b32 s57, s88, 8
    v_xor_b32 v6, s57, v4
    s_lshr_b32 s58, s87, 2
    s_add_u32 m0, s93, s58
    s_nop 0
    buffer_load_dwordx4 v6, s[4:7], s87 offen lds
    s_add_u32 s87, s88, 4096
    s_and_b32 s87, s87, 0xffff
    s_lshr_b32 s57, s87, 8
    v_xor_b32 v7, s57, v4
    s_lshr_b32 s58, s88, 2
    s_add_u32 m0, s93, s58
    s_nop 0
    buffer_load_dwordx4 v7, s[4:7], s88 offen lds
    s_add_u32 s88, s87, 4096
    s_and_b32 s88, s88, 0xffff
    s_lshr_b32 s57, s88, 8
    v_xor_b32 v6, s57, v4
    s_lshr_b32 s58, s87, 2
    s_add_u32 m0, s93, s58
    s_nop 0
    buffer_load_dwordx4 v6, s[4:7], s87 offen lds
    s_add_u32 s87, s88, 4096
    s_and_b32 s87, s87, 0xffff
    s_lshr_b32 s57, s87, 8
    v_xor_b32 v7, s57, v4
    s_lshr_b32 s58, s88, 2
    s_add_u32 m0, s93, s58
    s_nop 0
    buffer_load_dwordx4 v7, s[4:7], s88 offen lds
    s_add_u32 s88, s87, 4096
    s_and_b32 s88, s88, 0xffff
    s_lshr_b32 s57, s88, 8
    v_xor_b32 v6, s57, v4
    s_lshr_b32 s58, s87, 2
    s_add_u32 m0, s93, s58
    s_nop 0
    buffer_load_dwordx4 v6, s[4:7], s87 offen lds
    s_add_u32 s87, s88, 4096
    s_and_b32 s87, s87, 0xffff
    s_lshr_b32 s57, s87, 8
    v_xor_b32 v7, s57, v4
    s_lshr_b32 s58, s88, 2
    s_add_u32 m0, s93, s58
    s_nop 0
    buffer_load_dwordx4 v7, s[4:7], s88 offen lds
    s_add_u32 s88, s87, 4096
    s_and_b32 s88, s88, 0xffff
    s_lshr_b32 s57, s88, 8
    v_xor_b32 v6, s57, v4
    s_lshr_b32 s58, s87, 2
    s_add_u32 m0, s93, s58
    s_nop 0
    buffer_load_dwordx4 v6, s[4:7], s87 offen lds
    s_add_u32 s87, s88, 4096
    s_and_b32 s87, s87, 0xffff
    s_lshr_b32 s57, s87, 8
    v_xor_b32 v7, s57, v4
    s_lshr_b32 s58, s88, 2
    s_add_u32 m0, s93, s58
    s_nop 0
    buffer_load_dwordx4 v7, s[4:7], s88 offen lds
    s_add_u32 s88, s87, 4096
    s_and_b32 s88, s88, 0xffff
    s_lshr_b32 s57, s88, 8
    v_xor_b32 v6, s57, v4
    s_lshr_b32 s58, s87, 2
    s_add_u32 m0, s93, s58
    s_nop 0
    buffer_load_dwordx4 v6, s[4:7], s87 offen lds
    s_add_u32 s87, s88, 4096
    s_and_b32 s87, s87, 0xffff
    s_lshr_b32 s57, s87, 8
    v_xor_b32 v7, s57, v4
    s_lshr_b32 s58, s88, 2
    s_add_u32 m0, s93, s58
    s_nop 0
    buffer_load_dwordx4 v7, s[4:7], s88 offen lds
    s_mov_b32 s58, 5373952
    buffer_load_dword v254, v10, s[24:27], s58 offen sc1
    s_add_u32 s63, s63, 16384
    s_and_b32 s63, s63, 0x1ffff
    s_add_u32 m0, s54, 24576
    s_nop 0
    buffer_load_dwordx4 v8, s[8:11], s63 offen lds
    buffer_load_dwordx4 v9, s[8:11], s63 offen offset:1024 lds
    s_add_u32 m0, s54, 26624
    s_add_u32 s57, s63, 524288
    buffer_load_dwordx4 v8, s[8:11], s57 offen lds
    buffer_load_dwordx4 v9, s[8:11], s57 offen offset:1024 lds
    s_add_u32 m0, s54, 28672
    s_add_u32 s57, s63, 1048576
    buffer_load_dwordx4 v8, s[8:11], s57 offen lds
    buffer_load_dwordx4 v9, s[8:11], s57 offen offset:1024 lds
    s_add_u32 s63, s63, 16384
    s_and_b32 s63, s63, 0x1ffff
    s_add_u32 m0, s54, 30720
    s_nop 0
    buffer_load_dwordx4 v8, s[8:11], s63 offen lds
    buffer_load_dwordx4 v9, s[8:11], s63 offen offset:1024 lds
    v_and_b32 v1, 15, v0
    v_lshlrev_b32 v1, 2, v1
    v_bfe_u32 v2, v0, 4, 1
    v_lshl_add_u32 v1, v2, 1, v1
    v_add_u32 v1, 3, v1
    v_lshrrev_b32 v2, 5, v0
    v_add_u32 v3, 0, v1
    v_bfe_u32 v6, v3, 2, 4
    v_xor_b32 v6, v6, v2
    v_lshlrev_b32 v6, 4, v6
    v_lshl_add_u32 v6, v3, 8, v6
    v_add_u32 v12, s54, v6
    v_add_u32 v3, 1, v1
    v_bfe_u32 v6, v3, 2, 4
    v_xor_b32 v6, v6, v2
    v_lshlrev_b32 v6, 4, v6
    v_lshl_add_u32 v6, v3, 8, v6
    v_add_u32 v13, s54, v6
    v_add_u32 v3, 2, v1
    v_bfe_u32 v6, v3, 2, 4
    v_xor_b32 v6, v6, v2
    v_lshlrev_b32 v6, 4, v6
    v_lshl_add_u32 v6, v3, 8, v6
    v_add_u32 v14, s54, v6
    v_bfe_u32 v1, v0, 2, 2
    v_lshlrev_b32 v1, 7, v1
    v_lshl_add_u32 v1, v2, 10, v1
    v_and_b32 v3, 3, v0
    v_lshl_add_u32 v1, v3, 3, v1
    v_add_u32 v1, s54, v1
    v_bfe_u32 v3, v0, 4, 1
    v_bfe_u32 v6, v0, 3, 1
    v_lshl_or_b32 v3, v6, 1, v3
    v_lshl_add_u32 v4, v3, 5, v1
    v_xor_b32 v3, 2, v3
    v_lshl_add_u32 v5, v3, 5, v1
    s_waitcnt vmcnt(9)
    s_lshl_b32 s58, s55, 5
    v_xor_b32 v6, s58, v12
    ds_read_b128 v[16:19], v6
    v_xor_b32 v7, s58, v13
    ds_read_b128 v[20:23], v7
    v_xor_b32 v6, s58, v14
    ds_read_b128 v[24:27], v6
    s_add_u32 s58, s58, 32
    s_and_b32 s58, s58, 0xff
    v_xor_b32 v7, s58, v12
    ds_read_b128 v[28:31], v7
    v_xor_b32 v6, s58, v13
    ds_read_b128 v[32:35], v6
    v_xor_b32 v7, s58, v14
    ds_read_b128 v[36:39], v7
    s_add_u32 s58, s58, 32
    s_and_b32 s58, s58, 0xff
    v_xor_b32 v6, s58, v12
    ds_read_b128 v[40:43], v6
    v_xor_b32 v7, s58, v13
    ds_read_b128 v[44:47], v7
    v_xor_b32 v6, s58, v14
    ds_read_b128 v[48:51], v6
    s_add_u32 s58, s58, 32
    s_and_b32 s58, s58, 0xff
    v_xor_b32 v7, s58, v12
    ds_read_b128 v[52:55], v7
    v_xor_b32 v6, s58, v13
    ds_read_b128 v[56:59], v6
    v_xor_b32 v7, s58, v14
    ds_read_b128 v[60:63], v7
    s_add_u32 s58, s58, 32
    s_and_b32 s58, s58, 0xff
    v_xor_b32 v6, s58, v12
    ds_read_b128 v[64:67], v6
    v_xor_b32 v7, s58, v13
    ds_read_b128 v[68:71], v7
    v_xor_b32 v6, s58, v14
    ds_read_b128 v[72:75], v6
    s_add_u32 s58, s58, 32
    s_and_b32 s58, s58, 0xff
    v_xor_b32 v7, s58, v12
    ds_read_b128 v[76:79], v7
    v_xor_b32 v6, s58, v13
    ds_read_b128 v[80:83], v6
    v_xor_b32 v7, s58, v14
    ds_read_b128 v[84:87], v7
    s_add_u32 s58, s58, 32
    s_and_b32 s58, s58, 0xff
    v_xor_b32 v6, s58, v12
    ds_read_b128 v[88:91], v6
    v_xor_b32 v7, s58, v13
    ds_read_b128 v[92:95], v7
    v_xor_b32 v6, s58, v14
    ds_read_b128 v[96:99], v6
    s_add_u32 s58, s58, 32
    s_and_b32 s58, s58, 0xff
    v_xor_b32 v7, s58, v12
    ds_read_b128 v[100:103], v7
    v_xor_b32 v6, s58, v13
    ds_read_b128 v[104:107], v6
    v_xor_b32 v7, s58, v14
    ds_read_b128 v[108:111], v7
    s_add_u32 m0, s54, 32768
    s_add_u32 s57, s63, 524288
    buffer_load_dwordx4 v8, s[8:11], s57 offen lds
    buffer_load_dwordx4 v9, s[8:11], s57 offen offset:1024 lds
    s_add_u32 m0, s54, 34816
    s_add_u32 s57, s63, 1048576
    buffer_load_dwordx4 v8, s[8:11], s57 offen lds
    buffer_load_dwordx4 v9, s[8:11], s57 offen offset:1024 lds
    s_add_u32 s63, s63, 16384
    s_and_b32 s63, s63, 0x1ffff
    s_add_u32 m0, s54, 36864
    s_nop 0
    buffer_load_dwordx4 v8, s[8:11], s63 offen lds
    buffer_load_dwordx4 v9, s[8:11], s63 offen offset:1024 lds
    s_add_u32 m0, s54, 38912
    s_add_u32 s57, s63, 524288
    buffer_load_dwordx4 v8, s[8:11], s57 offen lds
    buffer_load_dwordx4 v9, s[8:11], s57 offen offset:1024 lds
    v_lshrrev_b32 v1, 2, v0
    v_and_b32 v1, 4, v1
    v_and_b32 v232, 7, v0
    v_xor_b32 v232, v232, v1
    v_lshlrev_b32 v232, 4, v232
    v_lshrrev_b32 v1, 3, v0
    v_lshl_add_u32 v232, v1, 10, v232
    v_xor_b32 v233, 32, v232
    v_add_u32 v233, 7168, v233
    v_add_u32 v234, 14336, v232
    v_add_u32 v235, 14336, v233
    s_lshl_b32 s57, s44, 8
    s_lshl_b32 s58, s44, 17
    v_add_u32 v236, s57, v232
    v_add_u32 v237, s57, v233
    v_add_u32 v238, s57, v234
    v_add_u32 v239, s57, v235
    v_add_u32 v232, s58, v232
    v_add_u32 v233, s58, v233
    v_add_u32 v234, s58, v234
    v_add_u32 v235, s58, v235
    v_lshrrev_b32 v1, 4, v0
    v_bfe_u32 v2, v0, 2, 2
    v_lshlrev_b32 v2, 7, v2
    v_lshl_add_u32 v2, v1, 10, v2
    v_and_b32 v3, 3, v0
    v_lshl_add_u32 v2, v3, 3, v2
    v_add_u32 v2, s54, v2
    v_bfe_u32 v3, v0, 3, 1
    v_lshlrev_b32 v3, 1, v3
    v_and_b32 v1, 1, v1
    v_or_b32 v3, v3, v1
    v_xor_b32 v1, 0, v3
    v_lshl_add_u32 v240, v1, 5, v2
    v_xor_b32 v1, 1, v3
    v_lshl_add_u32 v241, v1, 5, v2
    v_xor_b32 v1, 2, v3
    v_lshl_add_u32 v242, v1, 5, v2
    v_xor_b32 v1, 3, v3
    v_lshl_add_u32 v243, v1, 5, v2
    s_lshr_b32 s58, s46, 3
    s_and_b32 s59, s46, 7
    s_lshl_b32 s60, s45, 3
    s_add_u32 s59, s59, s60
    s_lshl_b32 s60, s58, 7
    s_lshl_b32 s61, s44, 5
    s_add_u32 s60, s60, s61
    v_and_b32 v1, 31, v0
    v_add_u32 v1, s60, v1
    v_lshlrev_b32 v1, 10, v1
    s_lshl_b32 s61, s59, 4
    v_add_u32 v15, s61, v1
    v_mov_b32 v1, s86
    v_cmp_gt_u32 vcc, 32, v0
    s_nop 1
    v_cndmask_b32 v15, v1, v15, vcc
    v_and_b32 v1, 15, v0
    v_lshlrev_b32 v1, 10, v1
    v_lshrrev_b32 v3, 4, v0
    v_lshl_add_u32 v1, v3, 4, v1
    s_lshl_b32 s60, s60, 1
    v_add_u32 v244, s60, v1
    v_lshlrev_b32 v1, 7, v3
    v_bfe_u32 v3, v0, 2, 2
    v_lshl_add_u32 v1, v3, 4, v1
    v_and_b32 v3, 1, v0
    v_lshl_add_u32 v1, v3, 3, v1
    s_add_u32 s60, s54, 26624
    v_add_u32 v245, s60, v1
    s_lshl_b32 s58, s58, 14
    s_lshl_b32 s59, s59, 7
    s_add_u32 s58, s58, s59
    s_add_u32 s93, s58, 5242880
    v_lshrrev_b32 v1, 5, v0
    v_lshlrev_b32 v1, 13, v1
    v_and_b32 v3, 15, v0
    v_lshl_add_u32 v1, v3, 4, v1
    v_bfe_u32 v6, v0, 4, 1
    v_lshl_add_u32 v1, v6, 3, v1
    s_cmp_eq_u32 s44, 0
    s_cselect_b32 s59, 8, 0
    v_cmp_gt_u32 vcc, s59, v3
    v_mov_b32 v6, s86
    s_nop 0
    v_cndmask_b32 v246, v6, v1, vcc
    s_waitcnt lgkmcnt(0)
    s_waitcnt vmcnt(16)
    v_add_u32 v254, 1, v254
    v_or_b32 v254, 0x80000000, v254
    s_waitcnt vmcnt(35)
    ds_read_b64_tr_b16 v[112:113], v4 offset:18432
    ds_read_b64_tr_b16 v[114:115], v4 offset:18944
    ds_read_b64_tr_b16 v[116:117], v5 offset:18432
    ds_read_b64_tr_b16 v[118:119], v5 offset:18944
    s_add_u32 m0, s54, 0
    s_add_u32 s57, s63, 1048576
    buffer_load_dwordx4 v8, s[8:11], s57 offen lds
    buffer_load_dwordx4 v9, s[8:11], s57 offen offset:1024 lds
    s_waitcnt vmcnt(35)
    ds_read_b64_tr_b16 v[120:121], v4 offset:20480
    ds_read_b64_tr_b16 v[122:123], v4 offset:20992
    ds_read_b64_tr_b16 v[124:125], v5 offset:20480
    ds_read_b64_tr_b16 v[126:127], v5 offset:20992
    s_waitcnt lgkmcnt(4)
    v_mfma_f32_32x32x16_bf16 v[128:143], v[112:115], v[16:19], 0
    v_mfma_f32_32x32x16_bf16 v[144:159], v[116:119], v[16:19], 0
    s_add_u32 s63, s63, 16384
    s_and_b32 s63, s63, 0x1ffff
    s_add_u32 m0, s54, 2048
    s_nop 0
    buffer_load_dwordx4 v8, s[8:11], s63 offen lds
    buffer_load_dwordx4 v9, s[8:11], s63 offen offset:1024 lds
    s_waitcnt vmcnt(35)
    ds_read_b64_tr_b16 v[112:113], v4 offset:22528
    ds_read_b64_tr_b16 v[114:115], v4 offset:23040
    ds_read_b64_tr_b16 v[116:117], v5 offset:22528
    ds_read_b64_tr_b16 v[118:119], v5 offset:23040
    s_waitcnt lgkmcnt(4)
    v_mfma_f32_32x32x16_bf16 v[128:143], v[120:123], v[20:23], v[128:143]
    v_mfma_f32_32x32x16_bf16 v[144:159], v[124:127], v[20:23], v[144:159]
    s_add_u32 m0, s54, 4096
    s_add_u32 s57, s63, 524288
    buffer_load_dwordx4 v8, s[8:11], s57 offen lds
    buffer_load_dwordx4 v9, s[8:11], s57 offen offset:1024 lds
    s_waitcnt vmcnt(20)
    ds_read_b64_tr_b16 v[120:121], v4 offset:24576
    ds_read_b64_tr_b16 v[122:123], v4 offset:25088
    ds_read_b64_tr_b16 v[124:125], v5 offset:24576
    ds_read_b64_tr_b16 v[126:127], v5 offset:25088
    s_waitcnt lgkmcnt(4)
    v_mfma_f32_32x32x16_bf16 v[128:143], v[112:115], v[24:27], v[128:143]
    v_mfma_f32_32x32x16_bf16 v[144:159], v[116:119], v[24:27], v[144:159]
    s_add_u32 m0, s54, 6144
    s_add_u32 s57, s63, 1048576
    buffer_load_dwordx4 v8, s[8:11], s57 offen lds
    buffer_load_dwordx4 v9, s[8:11], s57 offen offset:1024 lds
    s_waitcnt vmcnt(20)
    ds_read_b64_tr_b16 v[112:113], v4 offset:26624
    ds_read_b64_tr_b16 v[114:115], v4 offset:27136
    ds_read_b64_tr_b16 v[116:117], v5 offset:26624
    ds_read_b64_tr_b16 v[118:119], v5 offset:27136
    s_waitcnt lgkmcnt(4)
    v_mfma_f32_32x32x16_bf16 v[128:143], v[120:123], v[28:31], v[128:143]
    v_mfma_f32_32x32x16_bf16 v[144:159], v[124:127], v[28:31], v[144:159]
    s_add_u32 s63, s63, 16384
    s_and_b32 s63, s63, 0x1ffff
    s_add_u32 m0, s54, 8192
    s_nop 0
    buffer_load_dwordx4 v8, s[8:11], s63 offen lds
    buffer_load_dwordx4 v9, s[8:11], s63 offen offset:1024 lds
    s_waitcnt vmcnt(20)
    ds_read_b64_tr_b16 v[120:121], v4 offset:28672
    ds_read_b64_tr_b16 v[122:123], v4 offset:29184
    ds_read_b64_tr_b16 v[124:125], v5 offset:28672
    ds_read_b64_tr_b16 v[126:127], v5 offset:29184
    s_waitcnt lgkmcnt(4)
    v_mfma_f32_32x32x16_bf16 v[128:143], v[112:115], v[32:35], v[128:143]
    v_mfma_f32_32x32x16_bf16 v[144:159], v[116:119], v[32:35], v[144:159]
    s_add_u32 m0, s54, 10240
    s_add_u32 s57, s63, 524288
    buffer_load_dwordx4 v8, s[8:11], s57 offen lds
    buffer_load_dwordx4 v9, s[8:11], s57 offen offset:1024 lds
    s_waitcnt vmcnt(20)
    ds_read_b64_tr_b16 v[112:113], v4 offset:30720
    ds_read_b64_tr_b16 v[114:115], v4 offset:31232
    ds_read_b64_tr_b16 v[116:117], v5 offset:30720
    ds_read_b64_tr_b16 v[118:119], v5 offset:31232
    s_waitcnt lgkmcnt(4)
    v_mfma_f32_32x32x16_bf16 v[128:143], v[120:123], v[36:39], v[128:143]
    v_mfma_f32_32x32x16_bf16 v[144:159], v[124:127], v[36:39], v[144:159]
    s_add_u32 m0, s54, 12288
    s_add_u32 s57, s63, 1048576
    buffer_load_dwordx4 v8, s[8:11], s57 offen lds
    buffer_load_dwordx4 v9, s[8:11], s57 offen offset:1024 lds
    s_waitcnt vmcnt(20)
    ds_read_b64_tr_b16 v[120:121], v4 offset:32768
    ds_read_b64_tr_b16 v[122:123], v4 offset:33280
    ds_read_b64_tr_b16 v[124:125], v5 offset:32768
    ds_read_b64_tr_b16 v[126:127], v5 offset:33280
    s_waitcnt lgkmcnt(4)
    v_mfma_f32_32x32x16_bf16 v[128:143], v[112:115], v[40:43], v[128:143]
    v_mfma_f32_32x32x16_bf16 v[144:159], v[116:119], v[40:43], v[144:159]
    s_add_u32 s63, s63, 16384
    s_and_b32 s63, s63, 0x1ffff
    s_add_u32 m0, s54, 14336
    s_nop 0
    buffer_load_dwordx4 v8, s[8:11], s63 offen lds
    buffer_load_dwordx4 v9, s[8:11], s63 offen offset:1024 lds
    s_waitcnt vmcnt(20)
    ds_read_b64_tr_b16 v[112:113], v4 offset:34816
    ds_read_b64_tr_b16 v[114:115], v4 offset:35328
    ds_read_b64_tr_b16 v[116:117], v5 offset:34816
    ds_read_b64_tr_b16 v[118:119], v5 offset:35328
    s_waitcnt lgkmcnt(4)
    v_mfma_f32_32x32x16_bf16 v[128:143], v[120:123], v[44:47], v[128:143]
    v_mfma_f32_32x32x16_bf16 v[144:159], v[124:127], v[44:47], v[144:159]
    s_add_u32 m0, s54, 16384
    s_add_u32 s57, s63, 524288
    buffer_load_dwordx4 v8, s[8:11], s57 offen lds
    buffer_load_dwordx4 v9, s[8:11], s57 offen offset:1024 lds
    s_waitcnt vmcnt(20)
    ds_read_b64_tr_b16 v[120:121], v4 offset:36864
    ds_read_b64_tr_b16 v[122:123], v4 offset:37376
    ds_read_b64_tr_b16 v[124:125], v5 offset:36864
    ds_read_b64_tr_b16 v[126:127], v5 offset:37376
    s_waitcnt lgkmcnt(4)
    v_mfma_f32_32x32x16_bf16 v[128:143], v[112:115], v[48:51], v[128:143]
    v_mfma_f32_32x32x16_bf16 v[144:159], v[116:119], v[48:51], v[144:159]
    s_add_u32 m0, s54, 18432
    s_add_u32 s57, s63, 1048576
    buffer_load_dwordx4 v8, s[8:11], s57 offen lds
    buffer_load_dwordx4 v9, s[8:11], s57 offen offset:1024 lds
    s_waitcnt vmcnt(20)
    ds_read_b64_tr_b16 v[112:113], v4 offset:38912
    ds_read_b64_tr_b16 v[114:115], v4 offset:39424
    ds_read_b64_tr_b16 v[116:117], v5 offset:38912
    ds_read_b64_tr_b16 v[118:119], v5 offset:39424
    s_waitcnt lgkmcnt(4)
    v_mfma_f32_32x32x16_bf16 v[128:143], v[120:123], v[52:55], v[128:143]
    v_mfma_f32_32x32x16_bf16 v[144:159], v[124:127], v[52:55], v[144:159]
    s_add_u32 s63, s63, 16384
    s_and_b32 s63, s63, 0x1ffff
    s_add_u32 m0, s54, 20480
    s_nop 0
    buffer_load_dwordx4 v8, s[8:11], s63 offen lds
    buffer_load_dwordx4 v9, s[8:11], s63 offen offset:1024 lds
    s_waitcnt vmcnt(20)
    ds_read_b64_tr_b16 v[120:121], v4 offset:0
    ds_read_b64_tr_b16 v[122:123], v4 offset:512
    ds_read_b64_tr_b16 v[124:125], v5 offset:0
    ds_read_b64_tr_b16 v[126:127], v5 offset:512
    s_waitcnt lgkmcnt(4)
    v_mfma_f32_32x32x16_bf16 v[128:143], v[112:115], v[56:59], v[128:143]
    v_mfma_f32_32x32x16_bf16 v[144:159], v[116:119], v[56:59], v[144:159]
    s_add_u32 m0, s54, 22528
    s_add_u32 s57, s63, 524288
    buffer_load_dwordx4 v8, s[8:11], s57 offen lds
    buffer_load_dwordx4 v9, s[8:11], s57 offen offset:1024 lds
    s_waitcnt vmcnt(20)
    ds_read_b64_tr_b16 v[112:113], v4 offset:2048
    ds_read_b64_tr_b16 v[114:115], v4 offset:2560
    ds_read_b64_tr_b16 v[116:117], v5 offset:2048
    ds_read_b64_tr_b16 v[118:119], v5 offset:2560
    s_waitcnt lgkmcnt(4)
    v_mfma_f32_32x32x16_bf16 v[128:143], v[120:123], v[60:63], v[128:143]
    v_mfma_f32_32x32x16_bf16 v[144:159], v[124:127], v[60:63], v[144:159]
    s_add_u32 m0, s54, 24576
    s_add_u32 s57, s63, 1048576
    buffer_load_dwordx4 v8, s[8:11], s57 offen lds
    buffer_load_dwordx4 v9, s[8:11], s57 offen offset:1024 lds
    s_add_u32 m0, s54, 26624
    s_nop 0
    buffer_load_dwordx4 v15, s[36:39], 0 offen lds
    buffer_load_dwordx4 v[160:163], v244, s[32:35], 0 offen
    s_waitcnt vmcnt(22)
    ds_read_b64_tr_b16 v[120:121], v4 offset:4096
    ds_read_b64_tr_b16 v[122:123], v4 offset:4608
    ds_read_b64_tr_b16 v[124:125], v5 offset:4096
    ds_read_b64_tr_b16 v[126:127], v5 offset:4608
    s_waitcnt lgkmcnt(4)
    v_mfma_f32_32x32x16_bf16 v[128:143], v[112:115], v[64:67], v[128:143]
    v_mfma_f32_32x32x16_bf16 v[144:159], v[116:119], v[64:67], v[144:159]
    s_barrier
    buffer_load_dword v172, v247, s[12:15], 0 offen
    buffer_load_dword v173, v248, s[16:19], 0 offen
    buffer_load_dword v174, v249, s[20:23], 0 offen
    s_waitcnt vmcnt(23)
    ds_read_b64_tr_b16 v[112:113], v4 offset:6144
    ds_read_b64_tr_b16 v[114:115], v4 offset:6656
    ds_read_b64_tr_b16 v[116:117], v5 offset:6144
    ds_read_b64_tr_b16 v[118:119], v5 offset:6656
    s_waitcnt lgkmcnt(4)
    v_mfma_f32_32x32x16_bf16 v[128:143], v[120:123], v[68:71], v[128:143]
    v_mfma_f32_32x32x16_bf16 v[144:159], v[124:127], v[68:71], v[144:159]
    s_waitcnt vmcnt(21)
    ds_read_b64_tr_b16 v[120:121], v4 offset:8192
    ds_read_b64_tr_b16 v[122:123], v4 offset:8704
    ds_read_b64_tr_b16 v[124:125], v5 offset:8192
    ds_read_b64_tr_b16 v[126:127], v5 offset:8704
    s_waitcnt lgkmcnt(4)
    v_mfma_f32_32x32x16_bf16 v[128:143], v[112:115], v[72:75], v[128:143]
    v_mfma_f32_32x32x16_bf16 v[144:159], v[116:119], v[72:75], v[144:159]
    s_waitcnt vmcnt(19)
    ds_read_b64_tr_b16 v[112:113], v4 offset:10240
    ds_read_b64_tr_b16 v[114:115], v4 offset:10752
    ds_read_b64_tr_b16 v[116:117], v5 offset:10240
    ds_read_b64_tr_b16 v[118:119], v5 offset:10752
    s_waitcnt lgkmcnt(4)
    v_mfma_f32_32x32x16_bf16 v[128:143], v[120:123], v[76:79], v[128:143]
    v_mfma_f32_32x32x16_bf16 v[144:159], v[124:127], v[76:79], v[144:159]
    s_waitcnt vmcnt(17)
    ds_read_b64_tr_b16 v[120:121], v4 offset:12288
    ds_read_b64_tr_b16 v[122:123], v4 offset:12800
    ds_read_b64_tr_b16 v[124:125], v5 offset:12288
    ds_read_b64_tr_b16 v[126:127], v5 offset:12800
    s_waitcnt lgkmcnt(4)
    v_mfma_f32_32x32x16_bf16 v[128:143], v[112:115], v[80:83], v[128:143]
    v_mfma_f32_32x32x16_bf16 v[144:159], v[116:119], v[80:83], v[144:159]
    s_waitcnt vmcnt(15)
    ds_read_b64_tr_b16 v[112:113], v4 offset:14336
    ds_read_b64_tr_b16 v[114:115], v4 offset:14848
    ds_read_b64_tr_b16 v[116:117], v5 offset:14336
    ds_read_b64_tr_b16 v[118:119], v5 offset:14848
    s_waitcnt lgkmcnt(4)
    v_mfma_f32_32x32x16_bf16 v[128:143], v[120:123], v[84:87], v[128:143]
    v_mfma_f32_32x32x16_bf16 v[144:159], v[124:127], v[84:87], v[144:159]
    s_waitcnt vmcnt(13)
    ds_read_b64_tr_b16 v[120:121], v4 offset:16384
    ds_read_b64_tr_b16 v[122:123], v4 offset:16896
    ds_read_b64_tr_b16 v[124:125], v5 offset:16384
    ds_read_b64_tr_b16 v[126:127], v5 offset:16896
    s_waitcnt lgkmcnt(4)
    v_mfma_f32_32x32x16_bf16 v[128:143], v[112:115], v[88:91], v[128:143]
    v_mfma_f32_32x32x16_bf16 v[144:159], v[116:119], v[88:91], v[144:159]
    s_waitcnt vmcnt(11)
    ds_read_b64_tr_b16 v[112:113], v4 offset:18432
    ds_read_b64_tr_b16 v[114:115], v4 offset:18944
    ds_read_b64_tr_b16 v[116:117], v5 offset:18432
    ds_read_b64_tr_b16 v[118:119], v5 offset:18944
    s_waitcnt lgkmcnt(4)
    v_mfma_f32_32x32x16_bf16 v[128:143], v[120:123], v[92:95], v[128:143]
    v_mfma_f32_32x32x16_bf16 v[144:159], v[124:127], v[92:95], v[144:159]
    s_waitcnt vmcnt(9)
    s_waitcnt vmcnt(3)
    ds_read_b64_tr_b16 v[164:165], v245
    ds_read_b64_tr_b16 v[166:167], v245 offset:64
    ds_read_b64_tr_b16 v[120:121], v4 offset:20480
    ds_read_b64_tr_b16 v[122:123], v4 offset:20992
    ds_read_b64_tr_b16 v[124:125], v5 offset:20480
    ds_read_b64_tr_b16 v[126:127], v5 offset:20992
    s_waitcnt lgkmcnt(4)
    v_mfma_f32_32x32x16_bf16 v[128:143], v[112:115], v[96:99], v[128:143]
    v_mfma_f32_32x32x16_bf16 v[144:159], v[116:119], v[96:99], v[144:159]
    s_waitcnt vmcnt(7)
    ds_read_b64_tr_b16 v[112:113], v4 offset:22528
    ds_read_b64_tr_b16 v[114:115], v4 offset:23040
    ds_read_b64_tr_b16 v[116:117], v5 offset:22528
    ds_read_b64_tr_b16 v[118:119], v5 offset:23040
    s_waitcnt lgkmcnt(4)
    v_mfma_f32_32x32x16_bf16 v[128:143], v[120:123], v[100:103], v[128:143]
    v_mfma_f32_32x32x16_bf16 v[144:159], v[124:127], v[100:103], v[144:159]
    v_mfma_f32_16x16x32_bf16 v[168:171], v[160:163], v[164:167], 0
    s_waitcnt vmcnt(5)
    ds_read_b64_tr_b16 v[120:121], v4 offset:24576
    ds_read_b64_tr_b16 v[122:123], v4 offset:25088
    ds_read_b64_tr_b16 v[124:125], v5 offset:24576
    ds_read_b64_tr_b16 v[126:127], v5 offset:25088
    s_waitcnt lgkmcnt(4)
    v_mfma_f32_32x32x16_bf16 v[128:143], v[112:115], v[104:107], v[128:143]
    v_mfma_f32_32x32x16_bf16 v[144:159], v[116:119], v[104:107], v[144:159]
    s_waitcnt lgkmcnt(0)
    v_mfma_f32_32x32x16_bf16 v[128:143], v[120:123], v[108:111], v[128:143]
    v_mfma_f32_32x32x16_bf16 v[144:159], v[124:127], v[108:111], v[144:159]
    v_lshlrev_b32 v1, 4, v0
    s_add_u32 s58, s54, 16384
    v_add_u32 v2, s58, v1
    v_lshrrev_b32 v8, 5, v0
    s_lshl_b32 s58, s44, 1
    v_add_u32 v8, s58, v8
    v_and_b32 v9, 31, v0
    v_lshlrev_b32 v9, 4, v9
    v_lshl_add_u32 v9, v8, 10, v9
    v_add_u32 v9, 16384, v9
    v_add_u32 v10, 81920, v9
    v_add_u32 v13, 27648, v1
    v_add_u32 v14, 109568, v1
    s_add_u32 s58, s54, 27648
    v_add_u32 v12, s58, v1
    ds_write_b128 v12, v[168:171]
    ds_write_b128 v2, v[128:131] offset:0
    ds_write_b128 v2, v[132:135] offset:1024
    ds_write_b128 v2, v[136:139] offset:2048
    ds_write_b128 v2, v[140:143] offset:3072
    ds_write_b128 v2, v[144:147] offset:4096
    ds_write_b128 v2, v[148:151] offset:5120
    ds_write_b128 v2, v[152:155] offset:6144
    ds_write_b128 v2, v[156:159] offset:7168
    v_bfe_u32 v11, v0, 4, 1
    v_lshlrev_b32 v11, 18, v11
    v_lshl_add_u32 v11, v8, 12, v11
    v_and_b32 v1, 15, v0
    v_lshl_add_u32 v11, v1, 4, v11
    s_lshl_b32 s58, s47, 19
    s_lshl_b32 s59, s49, 15
    s_add_u32 s58, s58, s59
    s_lshl_b32 s59, s48, 8
    s_add_u32 s89, s58, s59
    s_waitcnt lgkmcnt(0)
    s_barrier
    ds_read_b128 v[16:19], v9 offset:0
    ds_read_b128 v[20:23], v9 offset:512
    ds_read_b128 v[24:27], v9 offset:40960
    ds_read_b128 v[28:31], v9 offset:41472
    ds_read_b128 v[32:35], v10 offset:0
    ds_read_b128 v[36:39], v10 offset:512
    ds_read_b128 v[40:43], v10 offset:40960
    ds_read_b128 v[44:47], v10 offset:41472
    ds_read_b128 v[48:51], v13 offset:0
    ds_read_b128 v[52:55], v13 offset:40960
    ds_read_b128 v[56:59], v14 offset:0
    ds_read_b128 v[60:63], v14 offset:40960
    s_waitcnt lgkmcnt(8)
    v_pk_add_f32 v[64:65], v[16:17], v[24:25]
    v_pk_add_f32 v[66:67], v[18:19], v[26:27]
    v_pk_add_f32 v[68:69], v[20:21], v[28:29]
    v_pk_add_f32 v[70:71], v[22:23], v[30:31]
    s_waitcnt lgkmcnt(4)
    v_pk_add_f32 v[72:73], v[32:33], v[40:41]
    v_pk_add_f32 v[74:75], v[34:35], v[42:43]
    v_pk_add_f32 v[76:77], v[36:37], v[44:45]
    v_pk_add_f32 v[78:79], v[38:39], v[46:47]
    v_pk_add_f32 v[64:65], v[64:65], v[72:73]
    v_pk_add_f32 v[66:67], v[66:67], v[74:75]
    v_pk_add_f32 v[68:69], v[68:69], v[76:77]
    v_pk_add_f32 v[70:71], v[70:71], v[78:79]
    v_pk_mul_f32 v[72:73], v[64:65], v[64:65]
    v_pk_mul_f32 v[74:75], v[66:67], v[66:67]
    v_pk_mul_f32 v[76:77], v[68:69], v[68:69]
    v_pk_mul_f32 v[78:79], v[70:71], v[70:71]
    v_pk_fma_f32 v[72:73], v[72:73], s[84:85], v[252:253] op_sel_hi:[1,0,0]
    v_pk_fma_f32 v[74:75], v[74:75], s[84:85], v[252:253] op_sel_hi:[1,0,0]
    v_pk_fma_f32 v[76:77], v[76:77], s[84:85], v[252:253] op_sel_hi:[1,0,0]
    v_pk_fma_f32 v[78:79], v[78:79], s[84:85], v[252:253] op_sel_hi:[1,0,0]
    v_pk_mul_f32 v[72:73], v[72:73], v[64:65]
    v_pk_mul_f32 v[74:75], v[74:75], v[66:67]
    v_pk_mul_f32 v[76:77], v[76:77], v[68:69]
    v_pk_mul_f32 v[78:79], v[78:79], v[70:71]
    v_exp_f32 v72, v72
    v_exp_f32 v73, v73
    v_exp_f32 v74, v74
    v_exp_f32 v75, v75
    v_exp_f32 v76, v76
    v_exp_f32 v77, v77
    v_exp_f32 v78, v78
    v_exp_f32 v79, v79
    v_pk_add_f32 v[72:73], v[72:73], 1.0 op_sel_hi:[1,0]
    v_pk_add_f32 v[74:75], v[74:75], 1.0 op_sel_hi:[1,0]
    v_pk_add_f32 v[76:77], v[76:77], 1.0 op_sel_hi:[1,0]
    v_pk_add_f32 v[78:79], v[78:79], 1.0 op_sel_hi:[1,0]
    v_rcp_f32 v72, v72
    v_rcp_f32 v73, v73
    v_rcp_f32 v74, v74
    v_rcp_f32 v75, v75
    v_rcp_f32 v76, v76
    v_rcp_f32 v77, v77
    v_rcp_f32 v78, v78
    v_rcp_f32 v79, v79
    v_pk_mul_f32 v[64:65], v[64:65], v[72:73]
    v_pk_mul_f32 v[66:67], v[66:67], v[74:75]
    v_pk_mul_f32 v[68:69], v[68:69], v[76:77]
    v_pk_mul_f32 v[70:71], v[70:71], v[78:79]
    v_cvt_pk_bf16_f32 v80, v64, v65
    v_cvt_pk_bf16_f32 v81, v66, v67
    v_cvt_pk_bf16_f32 v82, v68, v69
    v_cvt_pk_bf16_f32 v83, v70, v71
    buffer_store_dwordx4 v[80:83], v11, s[24:27], s89 offen sc1
    s_waitcnt lgkmcnt(0)
    v_add_f32 v84, v48, v52
    v_add_f32 v88, v56, v60
    v_add_f32 v85, v49, v53
    v_add_f32 v89, v57, v61
    v_add_f32 v86, v50, v54
    v_add_f32 v90, v58, v62
    v_add_f32 v87, v51, v55
    v_add_f32 v91, v59, v63
    v_add_f32 v84, v84, v88
    v_add_f32 v85, v85, v89
    v_add_f32 v86, v86, v90
    v_add_f32 v87, v87, v91
    v_mul_f32 v84, s85, v84
    v_mul_f32 v85, s85, v85
    v_mul_f32 v86, s85, v86
    v_mul_f32 v87, s85, v87
    v_cvt_pk_bf16_f32 v88, v84, v85
    v_cvt_pk_bf16_f32 v89, v86, v87
    buffer_store_dwordx2 v[88:89], v246, s[24:27], s93 offen sc1
    s_add_u32 m0, s54, 28672
    s_lshl_b32 s63, s92, 15
    buffer_load_dwordx4 v232, s[12:15], s63 offen offset:0 lds
    buffer_load_dwordx4 v233, s[12:15], s63 offen offset:1024 lds
    buffer_load_dwordx4 v234, s[12:15], s63 offen offset:2048 lds
    buffer_load_dwordx4 v235, s[12:15], s63 offen offset:3072 lds
    s_add_u32 m0, s54, 32768
    s_add_u32 s57, s63, 524288
    buffer_load_dwordx4 v232, s[12:15], s57 offen offset:0 lds
    buffer_load_dwordx4 v233, s[12:15], s57 offen offset:1024 lds
    buffer_load_dwordx4 v234, s[12:15], s57 offen offset:2048 lds
    buffer_load_dwordx4 v235, s[12:15], s57 offen offset:3072 lds
    s_add_u32 m0, s54, 36864
    s_add_u32 s57, s63, 1048576
    buffer_load_dwordx4 v232, s[12:15], s57 offen offset:0 lds
    buffer_load_dwordx4 v233, s[12:15], s57 offen offset:1024 lds
    buffer_load_dwordx4 v234, s[12:15], s57 offen offset:2048 lds
    buffer_load_dwordx4 v235, s[12:15], s57 offen offset:3072 lds
    s_add_u32 m0, s54, 0
    s_add_u32 s63, s63, 32768
    s_and_b32 s63, s63, 0x1ffff
    buffer_load_dwordx4 v232, s[12:15], s63 offen offset:0 lds
    buffer_load_dwordx4 v233, s[12:15], s63 offen offset:1024 lds
    buffer_load_dwordx4 v234, s[12:15], s63 offen offset:2048 lds
    buffer_load_dwordx4 v235, s[12:15], s63 offen offset:3072 lds
    s_waitcnt vmcnt(16)
    s_barrier
    s_cmp_lg_u32 s44, 0
    s_cbranch_scc1 Lfl_1
    s_lshl_b32 s58, s47, 4
    s_add_u32 s58, s58, s48
    s_lshl_b32 s58, s58, 3
    s_add_u32 s58, s58, s49
    s_lshl_b32 s58, s58, 7
    s_add_u32 s58, s58, 5378048
    v_mov_b32 v1, 0
    s_mov_b64 exec, 1
    buffer_store_dword v254, v1, s[24:27], s58 offen sc1
    s_mov_b64 exec, -1
Lfl_1:
    s_add_u32 m0, s54, 16384
    s_add_u32 s57, s63, 524288
    buffer_load_dwordx4 v232, s[12:15], s57 offen offset:0 lds
    buffer_load_dwordx4 v233, s[12:15], s57 offen offset:1024 lds
    buffer_load_dwordx4 v234, s[12:15], s57 offen offset:2048 lds
    buffer_load_dwordx4 v235, s[12:15], s57 offen offset:3072 lds
    s_add_u32 m0, s54, 20480
    s_add_u32 s57, s63, 1048576
    buffer_load_dwordx4 v232, s[12:15], s57 offen offset:0 lds
    buffer_load_dwordx4 v233, s[12:15], s57 offen offset:1024 lds
    buffer_load_dwordx4 v234, s[12:15], s57 offen offset:2048 lds
    buffer_load_dwordx4 v235, s[12:15], s57 offen offset:3072 lds
    v_and_b32 v13, 7, v0
    v_bfe_u32 v2, v0, 3, 1
    s_cmp_eq_u32 s51, 0
    s_cselect_b32 s58, 0, 8
    v_mul_lo_u32 v2, v2, s58
    v_sub_u32 v13, v13, v2
    s_lshl_b32 s58, s47, 4
    s_add_u32 s58, s58, s51
    s_lshl_b32 s58, s58, 3
    v_add_u32 v13, s58, v13
    v_lshlrev_b32 v13, 7, v13
    v_mov_b32 v2, s86
    v_cmp_gt_u32 vcc, 16, v0
    s_nop 1
    v_cndmask_b32 v13, v2, v13, vcc
    v_lshrrev_b32 v12, 2, v0
    s_lshl_b32 s58, s47, 4
    s_bfe_u32 s59, s45, 0x10001
    s_lshl_b32 s59, s59, 3
    s_add_u32 s58, s58, s59
    v_add_u32 v12, s58, v12
    v_lshlrev_b32 v12, 3, v12
    v_and_b32 v1, 3, v0
    v_add_u32 v12, v12, v1
    s_and_b32 s58, s45, 1
    s_lshl_b32 s58, s58, 2
    v_add_u32 v12, s58, v12
    v_lshlrev_b32 v12, 7, v12
    s_or_b32 s58, s46, s44
    s_cmp_eq_u32 s58, 0
    s_cselect_b32 s58, 32, 0
    v_cmp_gt_u32 vcc, s58, v0
    s_nop 1
    v_cndmask_b32 v12, v2, v12, vcc
    s_mov_b32 s89, 5378048
    v_and_b32 v5, 15, v0
    s_lshl_b32 s58, s51, 4
    v_add_u32 v5, s58, v5
    v_lshrrev_b32 v6, 4, v0
    v_lshlrev_b32 v6, 12, v6
    v_lshl_add_u32 v3, v5, 4, v6
    s_lshl_b32 s58, s44, 16
    v_add_u32 v3, s58, v3
    v_subrev_u32 v4, 16, v3
    v_mov_b32 v6, s86
    v_and_b32 v7, 15, v0
    v_cmp_ne_u32 vcc, 0, v7
    s_nop 1
    v_cndmask_b32 v4, v4, v6, vcc
    v_cmp_eq_u32 vcc, 0, v5
    s_nop 1
    v_cndmask_b32 v4, v4, v6, vcc
    s_waitcnt vmcnt(20)
    ds_read_b64_tr_b16 a[0:1], v240 offset:28672
    ds_read_b64_tr_b16 a[2:3], v240 offset:29184
    ds_read_b64_tr_b16 a[4:5], v241 offset:28672
    ds_read_b64_tr_b16 a[6:7], v241 offset:29184
    ds_read_b64_tr_b16 a[8:9], v242 offset:28672
    ds_read_b64_tr_b16 a[10:11], v242 offset:29184
    ds_read_b64_tr_b16 a[12:13], v243 offset:28672
    ds_read_b64_tr_b16 a[14:15], v243 offset:29184
    s_add_u32 m0, s54, 24576
    s_add_u32 s63, s63, 32768
    s_and_b32 s63, s63, 0x1ffff
    buffer_load_dwordx4 v232, s[12:15], s63 offen offset:0 lds
    buffer_load_dwordx4 v233, s[12:15], s63 offen offset:1024 lds
    buffer_load_dwordx4 v234, s[12:15], s63 offen offset:2048 lds
    buffer_load_dwordx4 v235, s[12:15], s63 offen offset:3072 lds
    s_waitcnt vmcnt(20)
    ds_read_b64_tr_b16 a[16:17], v240 offset:32768
    ds_read_b64_tr_b16 a[18:19], v240 offset:33280
    ds_read_b64_tr_b16 a[20:21], v241 offset:32768
    ds_read_b64_tr_b16 a[22:23], v241 offset:33280
    ds_read_b64_tr_b16 a[24:25], v242 offset:32768
    ds_read_b64_tr_b16 a[26:27], v242 offset:33280
    ds_read_b64_tr_b16 a[28:29], v243 offset:32768
    ds_read_b64_tr_b16 a[30:31], v243 offset:33280
    s_waitcnt lgkmcnt(8)
    s_add_u32 m0, s54, 4096
    s_add_u32 s57, s63, 524288
    buffer_load_dwordx4 v232, s[12:15], s57 offen offset:0 lds
    buffer_load_dwordx4 v233, s[12:15], s57 offen offset:1024 lds
    buffer_load_dwordx4 v234, s[12:15], s57 offen offset:2048 lds
    buffer_load_dwordx4 v235, s[12:15], s57 offen offset:3072 lds
    s_waitcnt vmcnt(20)
    ds_read_b64_tr_b16 a[32:33], v240 offset:36864
    ds_read_b64_tr_b16 a[34:35], v240 offset:37376
    ds_read_b64_tr_b16 a[36:37], v241 offset:36864
    ds_read_b64_tr_b16 a[38:39], v241 offset:37376
    ds_read_b64_tr_b16 a[40:41], v242 offset:36864
    ds_read_b64_tr_b16 a[42:43], v242 offset:37376
    ds_read_b64_tr_b16 a[44:45], v243 offset:36864
    ds_read_b64_tr_b16 a[46:47], v243 offset:37376
    s_waitcnt lgkmcnt(8)
    s_add_u32 m0, s54, 8192
    s_add_u32 s57, s63, 1048576
    buffer_load_dwordx4 v232, s[12:15], s57 offen offset:0 lds
    buffer_load_dwordx4 v233, s[12:15], s57 offen offset:1024 lds
    buffer_load_dwordx4 v234, s[12:15], s57 offen offset:2048 lds
    buffer_load_dwordx4 v235, s[12:15], s57 offen offset:3072 lds
    s_waitcnt vmcnt(20)
    ds_read_b64_tr_b16 a[48:49], v240 offset:0
    ds_read_b64_tr_b16 a[50:51], v240 offset:512
    ds_read_b64_tr_b16 a[52:53], v241 offset:0
    ds_read_b64_tr_b16 a[54:55], v241 offset:512
    ds_read_b64_tr_b16 a[56:57], v242 offset:0
    ds_read_b64_tr_b16 a[58:59], v242 offset:512
    ds_read_b64_tr_b16 a[60:61], v243 offset:0
    ds_read_b64_tr_b16 a[62:63], v243 offset:512
    s_waitcnt lgkmcnt(8)
    s_add_u32 m0, s54, 12288
    s_add_u32 s63, s63, 32768
    s_and_b32 s63, s63, 0x1ffff
    buffer_load_dwordx4 v232, s[12:15], s63 offen offset:0 lds
    buffer_load_dwordx4 v233, s[12:15], s63 offen offset:1024 lds
    buffer_load_dwordx4 v234, s[12:15], s63 offen offset:2048 lds
    buffer_load_dwordx4 v235, s[12:15], s63 offen offset:3072 lds
    s_waitcnt vmcnt(20)
    ds_read_b64_tr_b16 a[64:65], v240 offset:16384
    ds_read_b64_tr_b16 a[66:67], v240 offset:16896
    ds_read_b64_tr_b16 a[68:69], v241 offset:16384
    ds_read_b64_tr_b16 a[70:71], v241 offset:16896
    ds_read_b64_tr_b16 a[72:73], v242 offset:16384
    ds_read_b64_tr_b16 a[74:75], v242 offset:16896
    ds_read_b64_tr_b16 a[76:77], v243 offset:16384
    ds_read_b64_tr_b16 a[78:79], v243 offset:16896
    s_waitcnt lgkmcnt(8)
    buffer_load_dword v14, v13, s[24:27], s89 offen sc1
    s_add_u32 m0, s54, 28672
    s_add_u32 s57, s63, 524288
    buffer_load_dwordx4 v232, s[12:15], s57 offen offset:0 lds
    buffer_load_dwordx4 v233, s[12:15], s57 offen offset:1024 lds
    buffer_load_dwordx4 v234, s[12:15], s57 offen offset:2048 lds
    buffer_load_dwordx4 v235, s[12:15], s57 offen offset:3072 lds
    s_waitcnt vmcnt(21)
    ds_read_b64_tr_b16 a[80:81], v240 offset:20480
    ds_read_b64_tr_b16 a[82:83], v240 offset:20992
    ds_read_b64_tr_b16 a[84:85], v241 offset:20480
    ds_read_b64_tr_b16 a[86:87], v241 offset:20992
    ds_read_b64_tr_b16 a[88:89], v242 offset:20480
    ds_read_b64_tr_b16 a[90:91], v242 offset:20992
    ds_read_b64_tr_b16 a[92:93], v243 offset:20480
    ds_read_b64_tr_b16 a[94:95], v243 offset:20992
    s_waitcnt lgkmcnt(8)
    s_add_u32 m0, s54, 32768
    s_add_u32 s57, s63, 1048576
    buffer_load_dwordx4 v232, s[12:15], s57 offen offset:0 lds
    buffer_load_dwordx4 v233, s[12:15], s57 offen offset:1024 lds
    buffer_load_dwordx4 v234, s[12:15], s57 offen offset:2048 lds
    buffer_load_dwordx4 v235, s[12:15], s57 offen offset:3072 lds
    s_waitcnt vmcnt(21)
    ds_read_b64_tr_b16 a[96:97], v240 offset:24576
    ds_read_b64_tr_b16 a[98:99], v240 offset:25088
    ds_read_b64_tr_b16 a[100:101], v241 offset:24576
    ds_read_b64_tr_b16 a[102:103], v241 offset:25088
    ds_read_b64_tr_b16 a[104:105], v242 offset:24576
    ds_read_b64_tr_b16 a[106:107], v242 offset:25088
    ds_read_b64_tr_b16 a[108:109], v243 offset:24576
    ds_read_b64_tr_b16 a[110:111], v243 offset:25088
    s_waitcnt vmcnt(17)
    ds_read_b64_tr_b16 a[112:113], v240 offset:4096
    ds_read_b64_tr_b16 a[114:115], v240 offset:4608
    ds_read_b64_tr_b16 a[116:117], v241 offset:4096
    ds_read_b64_tr_b16 a[118:119], v241 offset:4608
    ds_read_b64_tr_b16 a[120:121], v242 offset:4096
    ds_read_b64_tr_b16 a[122:123], v242 offset:4608
    ds_read_b64_tr_b16 a[124:125], v243 offset:4096
    ds_read_b64_tr_b16 a[126:127], v243 offset:4608
    s_waitcnt vmcnt(13)
    ds_read_b64_tr_b16 a[128:129], v240 offset:8192
    ds_read_b64_tr_b16 a[130:131], v240 offset:8704
    ds_read_b64_tr_b16 a[132:133], v241 offset:8192
    ds_read_b64_tr_b16 a[134:135], v241 offset:8704
    ds_read_b64_tr_b16 a[136:137], v242 offset:8192
    ds_read_b64_tr_b16 a[138:139], v242 offset:8704
    ds_read_b64_tr_b16 a[140:141], v243 offset:8192
    ds_read_b64_tr_b16 a[142:143], v243 offset:8704
    s_waitcnt vmcnt(9)
    ds_read_b64_tr_b16 a[144:145], v240 offset:12288
    ds_read_b64_tr_b16 a[146:147], v240 offset:12800
    ds_read_b64_tr_b16 a[148:149], v241 offset:12288
    ds_read_b64_tr_b16 a[150:151], v241 offset:12800
    ds_read_b64_tr_b16 a[152:153], v242 offset:12288
    ds_read_b64_tr_b16 a[154:155], v242 offset:12800
    ds_read_b64_tr_b16 a[156:157], v243 offset:12288
    ds_read_b64_tr_b16 a[158:159], v243 offset:12800
    s_waitcnt vmcnt(8)
    v_cmp_ne_u32 vcc, v254, v14
    s_and_b32 s94, vcc_lo, 0xffff
    s_cbranch_scc0 Lok_3
    s_mov_b32 s56, 32768
Lpoll_2:
    buffer_load_dword v14, v13, s[24:27], s89 offen sc1
    s_waitcnt vmcnt(0)
    v_cmp_ne_u32 vcc, v254, v14
    s_and_b32 s94, vcc_lo, 0xffff
    s_cbranch_scc0 Lok_3
    s_sub_u32 s56, s56, 1
    s_cmp_lg_u32 s56, 0
    s_cbranch_scc1 Lpoll_2
Lok_3:
    s_nop 1
    s_lshl_b32 s58, s47, 19
    s_lshl_b32 s59, s92, 14
    s_add_u32 s60, s58, s59
    s_add_u32 s61, s60, 262144
    buffer_load_dwordx4 v[16:19], v4, s[24:27], s61 offen
    buffer_load_dwordx4 v[20:23], v3, s[24:27], s60 offen
    buffer_load_dwordx4 v[24:27], v3, s[24:27], s61 offen
    s_add_u32 s59, s59, 16384
    s_and_b32 s59, s59, 0xffff
    s_add_u32 s60, s58, s59
    s_add_u32 s61, s60, 262144
    buffer_load_dwordx4 v[28:31], v4, s[24:27], s61 offen
    buffer_load_dwordx4 v[32:35], v3, s[24:27], s60 offen
    buffer_load_dwordx4 v[36:39], v3, s[24:27], s61 offen
    s_add_u32 s59, s59, 16384
    s_and_b32 s59, s59, 0xffff
    s_add_u32 s60, s58, s59
    s_add_u32 s61, s60, 262144
    buffer_load_dwordx4 v[40:43], v4, s[24:27], s61 offen
    buffer_load_dwordx4 v[44:47], v3, s[24:27], s60 offen
    buffer_load_dwordx4 v[48:51], v3, s[24:27], s61 offen
    s_add_u32 s59, s59, 16384
    s_and_b32 s59, s59, 0xffff
    s_add_u32 s60, s58, s59
    s_add_u32 s61, s60, 262144
    buffer_load_dwordx4 v[52:55], v4, s[24:27], s61 offen
    buffer_load_dwordx4 v[56:59], v3, s[24:27], s60 offen
    buffer_load_dwordx4 v[60:63], v3, s[24:27], s61 offen
    buffer_load_dword v15, v12, s[24:27], s89 offen sc1
    s_waitcnt vmcnt(17)
    ds_read_b64_tr_b16 a[160:161], v240 offset:28672
    ds_read_b64_tr_b16 a[162:163], v240 offset:29184
    ds_read_b64_tr_b16 a[164:165], v241 offset:28672
    ds_read_b64_tr_b16 a[166:167], v241 offset:29184
    ds_read_b64_tr_b16 a[168:169], v242 offset:28672
    ds_read_b64_tr_b16 a[170:171], v242 offset:29184
    ds_read_b64_tr_b16 a[172:173], v243 offset:28672
    ds_read_b64_tr_b16 a[174:175], v243 offset:29184
    s_waitcnt vmcnt(13)
    ds_read_b64_tr_b16 a[176:177], v240 offset:32768
    ds_read_b64_tr_b16 a[178:179], v240 offset:33280
    ds_read_b64_tr_b16 a[180:181], v241 offset:32768
    ds_read_b64_tr_b16 a[182:183], v241 offset:33280
    ds_read_b64_tr_b16 a[184:185], v242 offset:32768
    ds_read_b64_tr_b16 a[186:187], v242 offset:33280
    ds_read_b64_tr_b16 a[188:189], v243 offset:32768
    ds_read_b64_tr_b16 a[190:191], v243 offset:33280
    s_waitcnt lgkmcnt(0)
    s_add_u32 m0, s54, 0
    s_mov_b32 s57, 0
    buffer_load_dwordx4 v236, s[16:19], s57 offen offset:0 lds
    buffer_load_dwordx4 v237, s[16:19], s57 offen offset:1024 lds
    buffer_load_dwordx4 v238, s[16:19], s57 offen offset:2048 lds
    buffer_load_dwordx4 v239, s[16:19], s57 offen offset:3072 lds
    s_waitcnt vmcnt(15)
    v_mfma_f32_16x16x32_bf16 v[64:67], a[16:19], v[20:23], 0
    v_mfma_f32_16x16x32_bf16 v[68:71], a[20:23], v[20:23], 0
    v_mfma_f32_16x16x32_bf16 v[72:75], a[24:27], v[20:23], 0
    v_mfma_f32_16x16x32_bf16 v[76:79], a[28:31], v[20:23], 0
    s_waitcnt vmcnt(14)
    v_mov_b32_dpp v16, v24 row_shr:1 row_mask:0xf bank_mask:0xf
    v_mov_b32_dpp v17, v25 row_shr:1 row_mask:0xf bank_mask:0xf
    v_mov_b32_dpp v18, v26 row_shr:1 row_mask:0xf bank_mask:0xf
    v_mov_b32_dpp v19, v27 row_shr:1 row_mask:0xf bank_mask:0xf
    v_mfma_f32_16x16x32_bf16 v[64:67], a[32:35], v[24:27], v[64:67]
    v_mfma_f32_16x16x32_bf16 v[68:71], a[36:39], v[24:27], v[68:71]
    v_mfma_f32_16x16x32_bf16 v[72:75], a[40:43], v[24:27], v[72:75]
    v_mfma_f32_16x16x32_bf16 v[76:79], a[44:47], v[24:27], v[76:79]
    v_mfma_f32_16x16x32_bf16 v[64:67], a[0:3], v[16:19], v[64:67]
    v_mfma_f32_16x16x32_bf16 v[68:71], a[4:7], v[16:19], v[68:71]
    v_mfma_f32_16x16x32_bf16 v[72:75], a[8:11], v[16:19], v[72:75]
    v_mfma_f32_16x16x32_bf16 v[76:79], a[12:15], v[16:19], v[76:79]
    s_waitcnt vmcnt(12)
    v_mfma_f32_16x16x32_bf16 v[64:67], a[64:67], v[32:35], v[64:67]
    v_mfma_f32_16x16x32_bf16 v[68:71], a[68:71], v[32:35], v[68:71]
    v_mfma_f32_16x16x32_bf16 v[72:75], a[72:75], v[32:35], v[72:75]
    v_mfma_f32_16x16x32_bf16 v[76:79], a[76:79], v[32:35], v[76:79]
    s_waitcnt vmcnt(11)
    v_mov_b32_dpp v28, v36 row_shr:1 row_mask:0xf bank_mask:0xf
    v_mov_b32_dpp v29, v37 row_shr:1 row_mask:0xf bank_mask:0xf
    v_mov_b32_dpp v30, v38 row_shr:1 row_mask:0xf bank_mask:0xf
    v_mov_b32_dpp v31, v39 row_shr:1 row_mask:0xf bank_mask:0xf
    v_mfma_f32_16x16x32_bf16 v[64:67], a[80:83], v[36:39], v[64:67]
    v_mfma_f32_16x16x32_bf16 v[68:71], a[84:87], v[36:39], v[68:71]
    v_mfma_f32_16x16x32_bf16 v[72:75], a[88:91], v[36:39], v[72:75]
    v_mfma_f32_16x16x32_bf16 v[76:79], a[92:95], v[36:39], v[76:79]
    v_mfma_f32_16x16x32_bf16 v[64:67], a[48:51], v[28:31], v[64:67]
    v_mfma_f32_16x16x32_bf16 v[68:71], a[52:55], v[28:31], v[68:71]
    v_mfma_f32_16x16x32_bf16 v[72:75], a[56:59], v[28:31], v[72:75]
    v_mfma_f32_16x16x32_bf16 v[76:79], a[60:63], v[28:31], v[76:79]
    s_waitcnt vmcnt(9)
    v_mfma_f32_16x16x32_bf16 v[64:67], a[112:115], v[44:47], v[64:67]
    v_mfma_f32_16x16x32_bf16 v[68:71], a[116:119], v[44:47], v[68:71]
    v_mfma_f32_16x16x32_bf16 v[72:75], a[120:123], v[44:47], v[72:75]
    v_mfma_f32_16x16x32_bf16 v[76:79], a[124:127], v[44:47], v[76:79]
    s_waitcnt vmcnt(8)
    v_mov_b32_dpp v40, v48 row_shr:1 row_mask:0xf bank_mask:0xf
    v_mov_b32_dpp v41, v49 row_shr:1 row_mask:0xf bank_mask:0xf
    v_mov_b32_dpp v42, v50 row_shr:1 row_mask:0xf bank_mask:0xf
    v_mov_b32_dpp v43, v51 row_shr:1 row_mask:0xf bank_mask:0xf
    v_mfma_f32_16x16x32_bf16 v[64:67], a[128:131], v[48:51], v[64:67]
    v_mfma_f32_16x16x32_bf16 v[68:71], a[132:135], v[48:51], v[68:71]
    v_mfma_f32_16x16x32_bf16 v[72:75], a[136:139], v[48:51], v[72:75]
    v_mfma_f32_16x16x32_bf16 v[76:79], a[140:143], v[48:51], v[76:79]
    v_mfma_f32_16x16x32_bf16 v[64:67], a[96:99], v[40:43], v[64:67]
    v_mfma_f32_16x16x32_bf16 v[68:71], a[100:103], v[40:43], v[68:71]
    v_mfma_f32_16x16x32_bf16 v[72:75], a[104:107], v[40:43], v[72:75]
    v_mfma_f32_16x16x32_bf16 v[76:79], a[108:111], v[40:43], v[76:79]
    s_add_u32 m0, s54, 16384
    s_mov_b32 s57, 32768
    buffer_load_dwordx4 v236, s[16:19], s57 offen offset:0 lds
    buffer_load_dwordx4 v237, s[16:19], s57 offen offset:1024 lds
    buffer_load_dwordx4 v238, s[16:19], s57 offen offset:2048 lds
    buffer_load_dwordx4 v239, s[16:19], s57 offen offset:3072 lds
    s_waitcnt vmcnt(10)
    v_mfma_f32_16x16x32_bf16 v[64:67], a[160:163], v[56:59], v[64:67]
    v_mfma_f32_16x16x32_bf16 v[68:71], a[164:167], v[56:59], v[68:71]
    v_mfma_f32_16x16x32_bf16 v[72:75], a[168:171], v[56:59], v[72:75]
    v_mfma_f32_16x16x32_bf16 v[76:79], a[172:175], v[56:59], v[76:79]
    s_waitcnt vmcnt(9)
    v_mov_b32_dpp v52, v60 row_shr:1 row_mask:0xf bank_mask:0xf
    v_mov_b32_dpp v53, v61 row_shr:1 row_mask:0xf bank_mask:0xf
    v_mov_b32_dpp v54, v62 row_shr:1 row_mask:0xf bank_mask:0xf
    v_mov_b32_dpp v55, v63 row_shr:1 row_mask:0xf bank_mask:0xf
    v_mfma_f32_16x16x32_bf16 v[64:67], a[176:179], v[60:63], v[64:67]
    v_mfma_f32_16x16x32_bf16 v[68:71], a[180:183], v[60:63], v[68:71]
    v_mfma_f32_16x16x32_bf16 v[72:75], a[184:187], v[60:63], v[72:75]
    v_mfma_f32_16x16x32_bf16 v[76:79], a[188:191], v[60:63], v[76:79]
    v_mfma_f32_16x16x32_bf16 v[64:67], a[144:147], v[52:55], v[64:67]
    v_mfma_f32_16x16x32_bf16 v[68:71], a[148:151], v[52:55], v[68:71]
    v_mfma_f32_16x16x32_bf16 v[72:75], a[152:155], v[52:55], v[72:75]
    v_mfma_f32_16x16x32_bf16 v[76:79], a[156:159], v[52:55], v[76:79]
    s_or_b32 s58, s46, s44
    s_cmp_lg_u32 s58, 0
    s_cbranch_scc1 Llead_4
    s_waitcnt vmcnt(8)
    v_cmp_ne_u32 vcc, v254, v15
    s_and_b32 s94, vcc_lo, -1
    s_cbranch_scc0 Lok_6
    s_mov_b32 s56, 32768
Lpoll_5:
    buffer_load_dword v15, v12, s[24:27], s89 offen sc1
    s_waitcnt vmcnt(0)
    v_cmp_ne_u32 vcc, v254, v15
    s_and_b32 s94, vcc_lo, -1
    s_cbranch_scc0 Lok_6
    s_sub_u32 s56, s56, 1
    s_cmp_lg_u32 s56, 0
    s_cbranch_scc1 Lpoll_5
Lok_6:
    s_nop 1
    s_lshl_b32 s58, s45, 7
    s_add_u32 s58, s58, 5374976
    v_mov_b32 v1, 0
    s_mov_b64 exec, 1
    buffer_store_dword v254, v1, s[24:27], s58 offen sc1
    s_mov_b64 exec, -1
Llead_4:
    v_lshlrev_b32 v1, 4, v0
    s_add_u32 s58, s54, 32768
    v_add_u32 v2, s58, v1
    ds_write_b128 v2, v[64:67] offset:0
    ds_write_b128 v2, v[68:71] offset:1024
    ds_write_b128 v2, v[72:75] offset:2048
    ds_write_b128 v2, v[76:79] offset:3072
    s_lshl_b32 s58, s44, 10
    s_add_u32 s58, s58, 32768
    v_add_u32 v3, s58, v1
    v_add_u32 v4, 81920, v3
    s_waitcnt lgkmcnt(0)
    s_barrier
    ds_read_b128 v[80:83], v3 offset:0
    ds_read_b128 v[84:87], v3 offset:40960
    ds_read_b128 v[88:91], v4 offset:0
    ds_read_b128 v[92:95], v4 offset:40960
    s_add_u32 m0, s54, 20480
    s_mov_b32 s57, 128
    buffer_load_dwordx4 v236, s[16:19], s57 offen offset:0 lds
    buffer_load_dwordx4 v237, s[16:19], s57 offen offset:1024 lds
    buffer_load_dwordx4 v238, s[16:19], s57 offen offset:2048 lds
    buffer_load_dwordx4 v239, s[16:19], s57 offen offset:3072 lds
    v_and_b32 v5, 15, v0
    v_mul_u32_u24 v5, 144, v5
    v_lshrrev_b32 v7, 4, v0
    v_lshl_add_u32 v6, v7, 4, v5
    v_add_u32 v6, 36864, v6
    v_lshl_add_u32 v5, v7, 3, v5
    s_lshl_b32 s58, s44, 5
    s_add_u32 s58, s58, 36864
    v_add_u32 v5, s58, v5
    s_waitcnt lgkmcnt(0)
    v_pk_add_f32 v[96:97], v[80:81], v[84:85]
    v_pk_add_f32 v[98:99], v[82:83], v[86:87]
    v_pk_add_f32 v[100:101], v[88:89], v[92:93]
    v_pk_add_f32 v[102:103], v[90:91], v[94:95]
    s_waitcnt vmcnt(8)
    ds_read_b64_tr_b16 a[192:193], v240 offset:0
    ds_read_b64_tr_b16 a[194:195], v240 offset:512
    ds_read_b64_tr_b16 a[200:201], v241 offset:0
    ds_read_b64_tr_b16 a[202:203], v241 offset:512
    ds_read_b64_tr_b16 a[208:209], v242 offset:0
    ds_read_b64_tr_b16 a[210:211], v242 offset:512
    ds_read_b64_tr_b16 a[216:217], v243 offset:0
    ds_read_b64_tr_b16 a[218:219], v243 offset:512
    v_pk_add_f32 v[96:97], v[96:97], v[100:101]
    v_pk_add_f32 v[98:99], v[98:99], v[102:103]
    v_pk_mul_f32 v[100:101], v[96:97], v[96:97]
    v_pk_mul_f32 v[102:103], v[98:99], v[98:99]
    v_pk_fma_f32 v[100:101], v[100:101], s[84:85], v[252:253] op_sel_hi:[1,0,0]
    v_pk_fma_f32 v[102:103], v[102:103], s[84:85], v[252:253] op_sel_hi:[1,0,0]
    v_pk_mul_f32 v[100:101], v[100:101], v[96:97]
    v_pk_mul_f32 v[102:103], v[102:103], v[98:99]
    v_exp_f32 v100, v100
    v_exp_f32 v101, v101
    v_exp_f32 v102, v102
    v_exp_f32 v103, v103
    v_pk_mul_f32 v[96:97], v[96:97], s[84:85] op_sel:[0,1] op_sel_hi:[1,1]
    v_pk_mul_f32 v[98:99], v[98:99], s[84:85] op_sel:[0,1] op_sel_hi:[1,1]
    v_pk_add_f32 v[100:101], v[100:101], 1.0 op_sel_hi:[1,0]
    v_pk_add_f32 v[102:103], v[102:103], 1.0 op_sel_hi:[1,0]
    v_rcp_f32 v100, v100
    v_rcp_f32 v101, v101
    v_rcp_f32 v102, v102
    v_rcp_f32 v103, v103
    v_pk_mul_f32 v[96:97], v[96:97], v[100:101]
    v_pk_mul_f32 v[98:99], v[98:99], v[102:103]
    v_cvt_pk_bf16_f32 v104, v96, v97
    v_cvt_pk_bf16_f32 v105, v98, v99
    ds_write_b64 v5, v[104:105]
    s_add_u32 m0, s54, 24576
    s_mov_b32 s57, 32896
    buffer_load_dwordx4 v236, s[16:19], s57 offen offset:0 lds
    buffer_load_dwordx4 v237, s[16:19], s57 offen offset:1024 lds
    buffer_load_dwordx4 v238, s[16:19], s57 offen offset:2048 lds
    buffer_load_dwordx4 v239, s[16:19], s57 offen offset:3072 lds
    s_waitcnt vmcnt(8)
    ds_read_b64_tr_b16 a[196:197], v240 offset:16384
    ds_read_b64_tr_b16 a[198:199], v240 offset:16896
    ds_read_b64_tr_b16 a[204:205], v241 offset:16384
    ds_read_b64_tr_b16 a[206:207], v241 offset:16896
    ds_read_b64_tr_b16 a[212:213], v242 offset:16384
    ds_read_b64_tr_b16 a[214:215], v242 offset:16896
    ds_read_b64_tr_b16 a[220:221], v243 offset:16384
    ds_read_b64_tr_b16 a[222:223], v243 offset:16896
    s_waitcnt lgkmcnt(8)
    s_barrier
    ds_read_b128 v[108:111], v6
    ds_read_b128 v[112:115], v6 offset:64
    v_lshrrev_b32 v9, 2, v0
    v_and_b32 v9, 4, v9
    v_and_b32 v232, 7, v0
    v_xor_b32 v232, v232, v9
    v_lshlrev_b32 v232, 4, v232
    v_lshrrev_b32 v9, 3, v0
    v_lshl_add_u32 v232, v9, 10, v232
    s_lshl_b32 s58, s44, 7
    v_add_u32 v232, s58, v232
    v_add_u32 v233, 7168, v232
    v_add_u32 v234, 14336, v232
    v_add_u32 v235, 21504, v232
    v_lshrrev_b32 v9, 5, v0
    v_bfe_u32 v10, v0, 2, 2
    v_lshl_add_u32 v9, v9, 2, v10
    v_lshlrev_b32 v9, 7, v9
    v_and_b32 v10, 3, v0
    v_lshl_add_u32 v9, v10, 3, v9
    v_add_u32 v9, s54, v9
    v_bfe_u32 v10, v0, 4, 1
    v_bfe_u32 v11, v0, 3, 1
    v_lshl_or_b32 v10, v11, 1, v10
    v_lshl_add_u32 v236, v10, 5, v9
    v_xor_b32 v10, 2, v10
    v_lshl_add_u32 v237, v10, 5, v9
    s_add_u32 m0, s54, 4096
    s_mov_b32 s57, 0
    buffer_load_dwordx4 v232, s[20:23], s57 offen offset:0 lds
    buffer_load_dwordx4 v233, s[20:23], s57 offen offset:1024 lds
    buffer_load_dwordx4 v234, s[20:23], s57 offen offset:2048 lds
    buffer_load_dwordx4 v235, s[20:23], s57 offen offset:3072 lds
    s_waitcnt vmcnt(8)
    ds_read_b64_tr_b16 a[224:225], v240 offset:20480
    ds_read_b64_tr_b16 a[226:227], v240 offset:20992
    ds_read_b64_tr_b16 a[232:233], v241 offset:20480
    ds_read_b64_tr_b16 a[234:235], v241 offset:20992
    ds_read_b64_tr_b16 a[240:241], v242 offset:20480
    ds_read_b64_tr_b16 a[242:243], v242 offset:20992
    ds_read_b64_tr_b16 a[248:249], v243 offset:20480
    ds_read_b64_tr_b16 a[250:251], v243 offset:20992
    s_waitcnt vmcnt(4)
    ds_read_b64_tr_b16 a[228:229], v240 offset:24576
    ds_read_b64_tr_b16 a[230:231], v240 offset:25088
    ds_read_b64_tr_b16 a[236:237], v241 offset:24576
    ds_read_b64_tr_b16 a[238:239], v241 offset:25088
    ds_read_b64_tr_b16 a[244:245], v242 offset:24576
    ds_read_b64_tr_b16 a[246:247], v242 offset:25088
    ds_read_b64_tr_b16 a[252:253], v243 offset:24576
    ds_read_b64_tr_b16 a[254:255], v243 offset:25088
    v_lshrrev_b32 v7, 4, v0
    v_lshlrev_b32 v7, 15, v7
    v_and_b32 v8, 15, v0
    v_lshl_add_u32 v7, v8, 4, v7
    s_lshl_b32 s58, s44, 10
    v_add_u32 v7, s58, v7
    s_lshl_b32 s58, s47, 6
    s_lshl_b32 s59, s51, 2
    s_add_u32 s58, s58, s59
    s_lshl_b32 s58, s58, 15
    s_lshl_b32 s59, s50, 12
    s_add_u32 s58, s58, s59
    s_add_u32 s89, s58, 1048576
    s_waitcnt lgkmcnt(0)
    v_mfma_f32_16x16x32_bf16 v[128:131], v[108:111], a[192:195], 0
    v_mfma_f32_16x16x32_bf16 v[132:135], v[108:111], a[200:203], 0
    v_mfma_f32_16x16x32_bf16 v[136:139], v[108:111], a[208:211], 0
    v_mfma_f32_16x16x32_bf16 v[140:143], v[108:111], a[216:219], 0
    v_mfma_f32_16x16x32_bf16 v[144:147], v[108:111], a[224:227], 0
    v_mfma_f32_16x16x32_bf16 v[148:151], v[108:111], a[232:235], 0
    v_mfma_f32_16x16x32_bf16 v[152:155], v[108:111], a[240:243], 0
    v_mfma_f32_16x16x32_bf16 v[156:159], v[108:111], a[248:251], 0
    v_mfma_f32_16x16x32_bf16 v[128:131], v[112:115], a[196:199], v[128:131]
    v_mfma_f32_16x16x32_bf16 v[132:135], v[112:115], a[204:207], v[132:135]
    v_mfma_f32_16x16x32_bf16 v[136:139], v[112:115], a[212:215], v[136:139]
    v_mfma_f32_16x16x32_bf16 v[140:143], v[112:115], a[220:223], v[140:143]
    v_mfma_f32_16x16x32_bf16 v[144:147], v[112:115], a[228:231], v[144:147]
    v_mfma_f32_16x16x32_bf16 v[148:151], v[112:115], a[236:239], v[148:151]
    v_mfma_f32_16x16x32_bf16 v[152:155], v[112:115], a[244:247], v[152:155]
    v_mfma_f32_16x16x32_bf16 v[156:159], v[112:115], a[252:255], v[156:159]
    s_nop 0
    v_cvt_pk_bf16_f32 v160, v128, v129
    v_cvt_pk_bf16_f32 v161, v130, v131
    v_cvt_pk_bf16_f32 v162, v132, v133
    v_cvt_pk_bf16_f32 v163, v134, v135
    buffer_store_dwordx4 v[160:163], v7, s[24:27], s89 offen offset:0 sc1
    v_cvt_pk_bf16_f32 v164, v136, v137
    v_cvt_pk_bf16_f32 v165, v138, v139
    v_cvt_pk_bf16_f32 v166, v140, v141
    v_cvt_pk_bf16_f32 v167, v142, v143
    buffer_store_dwordx4 v[164:167], v7, s[24:27], s89 offen offset:256 sc1
    v_cvt_pk_bf16_f32 v168, v144, v145
    v_cvt_pk_bf16_f32 v169, v146, v147
    v_cvt_pk_bf16_f32 v170, v148, v149
    v_cvt_pk_bf16_f32 v171, v150, v151
    buffer_store_dwordx4 v[168:171], v7, s[24:27], s89 offen offset:512 sc1
    v_cvt_pk_bf16_f32 v172, v152, v153
    v_cvt_pk_bf16_f32 v173, v154, v155
    v_cvt_pk_bf16_f32 v174, v156, v157
    v_cvt_pk_bf16_f32 v175, v158, v159
    buffer_store_dwordx4 v[172:175], v7, s[24:27], s89 offen offset:768 sc1
    v_lshlrev_b32 v12, 7, v0
    v_mov_b32 v2, s86
    v_cmp_gt_u32 vcc, 8, v0
    s_nop 1
    v_cndmask_b32 v12, v2, v12, vcc
    s_mov_b32 s89, 5374976
    buffer_load_dword v4, v12, s[24:27], s89 offen sc1
    s_add_u32 m0, s54, 8192
    s_mov_b32 s57, 32768
    buffer_load_dwordx4 v232, s[20:23], s57 offen offset:0 lds
    buffer_load_dwordx4 v233, s[20:23], s57 offen offset:1024 lds
    buffer_load_dwordx4 v234, s[20:23], s57 offen offset:2048 lds
    buffer_load_dwordx4 v235, s[20:23], s57 offen offset:3072 lds
    s_add_u32 m0, s54, 28672
    s_mov_b32 s57, 131072
    buffer_load_dwordx4 v232, s[20:23], s57 offen offset:0 lds
    buffer_load_dwordx4 v233, s[20:23], s57 offen offset:1024 lds
    buffer_load_dwordx4 v234, s[20:23], s57 offen offset:2048 lds
    buffer_load_dwordx4 v235, s[20:23], s57 offen offset:3072 lds
    s_waitcnt vmcnt(13)
    ds_read_b64_tr_b16 a[0:1], v236 offset:4096
    ds_read_b64_tr_b16 a[2:3], v236 offset:5120
    ds_read_b64_tr_b16 a[4:5], v237 offset:4096
    ds_read_b64_tr_b16 a[6:7], v237 offset:5120
    ds_read_b64_tr_b16 a[8:9], v236 offset:6144
    ds_read_b64_tr_b16 a[10:11], v236 offset:7168
    ds_read_b64_tr_b16 a[12:13], v237 offset:6144
    ds_read_b64_tr_b16 a[14:15], v237 offset:7168
    v_bfe_u32 v2, v0, 3, 2
    v_and_b32 v3, 7, v0
    v_mov_b32 v8, 0x3f80
    v_mov_b32 v9, 0x3f800000
    v_mov_b32 v10, 0
    v_cmp_eq_u32 vcc, 0, v2
    s_nop 1
    v_cndmask_b32 v11, v10, v8, vcc
    v_cmp_eq_u32 vcc, 1, v2
    s_nop 1
    v_cndmask_b32 v176, v11, v9, vcc
    v_mov_b32 v178, v176
    v_cmp_eq_u32 vcc, 2, v2
    s_nop 1
    v_cndmask_b32 v11, v10, v8, vcc
    v_cmp_eq_u32 vcc, 3, v2
    s_nop 1
    v_cndmask_b32 v177, v11, v9, vcc
    v_mov_b32 v179, v177
    v_cmp_eq_u32 vcc, 0, v3
    s_nop 1
    v_cndmask_b32 v11, v10, v8, vcc
    v_cmp_eq_u32 vcc, 1, v3
    s_nop 1
    v_cndmask_b32 v180, v11, v9, vcc
    v_cmp_eq_u32 vcc, 2, v3
    s_nop 1
    v_cndmask_b32 v11, v10, v8, vcc
    v_cmp_eq_u32 vcc, 3, v3
    s_nop 1
    v_cndmask_b32 v181, v11, v9, vcc
    v_cmp_eq_u32 vcc, 4, v3
    s_nop 1
    v_cndmask_b32 v11, v10, v8, vcc
    v_cmp_eq_u32 vcc, 5, v3
    s_nop 1
    v_cndmask_b32 v182, v11, v9, vcc
    v_cmp_eq_u32 vcc, 6, v3
    s_nop 1
    v_cndmask_b32 v11, v10, v8, vcc
    v_cmp_eq_u32 vcc, 7, v3
    s_nop 1
    v_cndmask_b32 v183, v11, v9, vcc
    v_mov_b32 v48, 1.0
    v_mov_b32 v49, 1.0
    v_mov_b32 v50, -2.0
    v_mov_b32 v51, -2.0
    s_waitcnt lgkmcnt(0)
    s_waitcnt vmcnt(9)
    s_barrier
    s_cmp_lg_u32 s44, 0
    s_cbranch_scc1 Lfl_7
    s_lshl_b32 s58, s47, 4
    s_add_u32 s58, s58, s51
    s_lshl_b32 s58, s58, 3
    s_add_u32 s58, s58, s50
    s_lshl_b32 s58, s58, 7
    s_add_u32 s58, s58, 5410816
    v_mov_b32 v1, 0
    s_mov_b64 exec, 1
    buffer_store_dword v254, v1, s[24:27], s58 offen sc1
    s_mov_b64 exec, -1
Lfl_7:
    s_waitcnt lgkmcnt(0)
    s_waitcnt vmcnt(8)
    v_cmp_ne_u32 vcc, v254, v4
    s_and_b32 s94, vcc_lo, 0xff
    s_cbranch_scc0 Lok_9
    s_mov_b32 s56, 32768
Lpoll_8:
    buffer_load_dword v4, v12, s[24:27], s89 offen sc1
    s_waitcnt vmcnt(0)
    v_cmp_ne_u32 vcc, v254, v4
    s_and_b32 s94, vcc_lo, 0xff
    s_cbranch_scc0 Lok_9
    s_sub_u32 s56, s56, 1
    s_cmp_lg_u32 s56, 0
    s_cbranch_scc1 Lpoll_8
Lok_9:
    s_nop 1
    s_or_b32 s58, s2, s44
    s_cmp_lg_u32 s58, 0
    s_cbranch_scc1 Le_10
    v_mov_b32 v1, 0
    s_mov_b32 s58, 5373952
    s_mov_b64 exec, 1
    buffer_store_dword v254, v1, s[24:27], s58 offen sc1
    s_mov_b64 exec, -1
Le_10:
    v_lshrrev_b32 v1, 5, v0
    v_bfe_u32 v2, v0, 4, 1
    v_and_b32 v3, 15, v0
    v_lshl_add_u32 v2, v2, 5, v3
    s_lshl_b32 s58, s44, 7
    v_add_u32 v2, s58, v2
    v_lshlrev_b32 v2, 4, v2
    v_lshl_add_u32 v2, v1, 14, v2
    s_lshl_b32 s58, s47, 13
    s_add_u32 s58, s58, 5242880
    s_add_u32 s59, s58, 32768
    buffer_load_dwordx4 v[16:19], v2, s[24:27], s58 offen offset:0
    buffer_load_dwordx4 v[20:23], v2, s[24:27], s59 offen offset:0
    buffer_load_dwordx4 v[24:27], v2, s[24:27], s58 offen offset:256
    buffer_load_dwordx4 v[28:31], v2, s[24:27], s59 offen offset:256
    buffer_load_dwordx4 v[32:35], v2, s[24:27], s58 offen offset:1024
    buffer_load_dwordx4 v[36:39], v2, s[24:27], s59 offen offset:1024
    buffer_load_dwordx4 v[40:43], v2, s[24:27], s58 offen offset:1280
    buffer_load_dwordx4 v[44:47], v2, s[24:27], s59 offen offset:1280
    s_lshl_b32 s58, s47, 4
    s_lshr_b32 s59, s53, 2
    s_add_u32 s58, s58, s59
    s_lshl_b32 s58, s58, 3
    v_add_u32 v4, s58, v0
    v_lshlrev_b32 v4, 7, v4
    v_mov_b32 v5, s86
    v_cmp_gt_u32 vcc, 8, v0
    s_nop 1
    v_cndmask_b32 v4, v5, v4, vcc
    s_mov_b32 s89, 5410816
    s_add_u32 m0, s54, 12288
    s_mov_b32 s57, 163840
    buffer_load_dwordx4 v232, s[20:23], s57 offen offset:0 lds
    buffer_load_dwordx4 v233, s[20:23], s57 offen offset:1024 lds
    buffer_load_dwordx4 v234, s[20:23], s57 offen offset:2048 lds
    buffer_load_dwordx4 v235, s[20:23], s57 offen offset:3072 lds
    s_add_u32 m0, s54, 0
    s_mov_b32 s57, 262144
    buffer_load_dwordx4 v232, s[20:23], s57 offen offset:0 lds
    buffer_load_dwordx4 v233, s[20:23], s57 offen offset:1024 lds
    buffer_load_dwordx4 v234, s[20:23], s57 offen offset:2048 lds
    buffer_load_dwordx4 v235, s[20:23], s57 offen offset:3072 lds
    s_add_u32 m0, s54, 32768
    s_mov_b32 s57, 294912
    buffer_load_dwordx4 v232, s[20:23], s57 offen offset:0 lds
    buffer_load_dwordx4 v233, s[20:23], s57 offen offset:1024 lds
    buffer_load_dwordx4 v234, s[20:23], s57 offen offset:2048 lds
    buffer_load_dwordx4 v235, s[20:23], s57 offen offset:3072 lds
    buffer_load_dword v5, v4, s[24:27], s89 offen sc1
    s_waitcnt vmcnt(19)
    v_mfma_f32_32x32x16_bf16 v[64:79], v[16:19], v[180:183], 0
    v_mfma_f32_32x32x16_bf16 v[64:79], v[20:23], v[180:183], v[64:79]
    s_waitcnt vmcnt(17)
    v_mfma_f32_32x32x16_bf16 v[80:95], v[24:27], v[180:183], 0
    v_mfma_f32_32x32x16_bf16 v[80:95], v[28:31], v[180:183], v[80:95]
    s_waitcnt vmcnt(15)
    v_mfma_f32_32x32x16_bf16 v[96:111], v[32:35], v[180:183], 0
    v_mfma_f32_32x32x16_bf16 v[96:111], v[36:39], v[180:183], v[96:111]
    s_waitcnt vmcnt(13)
    v_mfma_f32_32x32x16_bf16 v[112:127], v[40:43], v[180:183], 0
    v_mfma_f32_32x32x16_bf16 v[112:127], v[44:47], v[180:183], v[112:127]
    s_add_u32 m0, s54, 16384
    s_mov_b32 s57, 393216
    buffer_load_dwordx4 v232, s[20:23], s57 offen offset:0 lds
    buffer_load_dwordx4 v233, s[20:23], s57 offen offset:1024 lds
    buffer_load_dwordx4 v234, s[20:23], s57 offen offset:2048 lds
    buffer_load_dwordx4 v235, s[20:23], s57 offen offset:3072 lds
    s_add_u32 m0, s54, 20480
    s_mov_b32 s57, 425984
    buffer_load_dwordx4 v232, s[20:23], s57 offen offset:0 lds
    buffer_load_dwordx4 v233, s[20:23], s57 offen offset:1024 lds
    buffer_load_dwordx4 v234, s[20:23], s57 offen offset:2048 lds
    buffer_load_dwordx4 v235, s[20:23], s57 offen offset:3072 lds
    v_lshrrev_b32 v1, 5, v0
    v_lshlrev_b32 v1, 13, v1
    v_and_b32 v2, 31, v0
    v_lshl_add_u32 v1, v2, 4, v1
    s_lshl_b32 s58, s44, 10
    v_add_u32 v1, s58, v1
    s_lshl_b32 s58, s47, 6
    s_add_u32 s58, s58, s53
    s_lshl_b32 s58, s58, 15
    s_add_u32 s58, s58, 1048576
    s_add_u32 s59, s58, 4096
    s_add_u32 s60, s58, 16384
    s_add_u32 s61, s58, 20480
    v_lshlrev_b32 v7, 4, v0
    v_add_u32 v6, s54, v7
    v_add_u32 v8, 81920, v7
    v_and_b32 v2, 31, v0
    v_lshlrev_b32 v9, 7, v2
    v_lshrrev_b32 v3, 5, v0
    v_lshl_add_u32 v9, v3, 3, v9
    s_add_u32 s62, s54, 8192
    v_add_u32 v9, s62, v9
    v_and_b32 v12, 7, v2
    v_lshrrev_b32 v2, 3, v0
    v_and_b32 v3, 7, v0
    v_xor_b32 v10, v2, v3
    v_lshlrev_b32 v10, 4, v10
    v_lshl_add_u32 v10, v2, 7, v10
    v_add_u32 v10, s62, v10
    v_lshlrev_b32 v11, 4, v3
    v_lshl_add_u32 v11, v2, 10, v11
    s_lshl_b32 s62, s44, 7
    v_add_u32 v11, s62, v11
    v_xor_b32 v216, 0, v12
    v_lshl_add_u32 v216, v216, 4, v9
    v_xor_b32 v217, 1, v12
    v_lshl_add_u32 v217, v217, 4, v9
    v_xor_b32 v218, 2, v12
    v_lshl_add_u32 v218, v218, 4, v9
    v_xor_b32 v219, 3, v12
    v_lshl_add_u32 v219, v219, 4, v9
    v_xor_b32 v220, 4, v12
    v_lshl_add_u32 v220, v220, 4, v9
    v_xor_b32 v221, 5, v12
    v_lshl_add_u32 v221, v221, 4, v9
    v_xor_b32 v222, 6, v12
    v_lshl_add_u32 v222, v222, 4, v9
    v_xor_b32 v223, 7, v12
    v_lshl_add_u32 v223, v223, 4, v9
    v_lshrrev_b32 v2, 2, v0
    v_and_b32 v3, 9, v2
    v_and_b32 v12, 2, v2
    v_lshl_or_b32 v3, v12, 1, v3
    v_and_b32 v12, 4, v2
    v_lshrrev_b32 v12, 1, v12
    v_or_b32 v2, v12, v3
    v_and_b32 v3, 3, v0
    v_and_b32 v12, 7, v2
    v_xor_b32 v12, v12, v3
    v_lshlrev_b32 v12, 4, v12
    v_lshl_add_u32 v12, v2, 7, v12
    s_add_u32 s62, s54, 8192
    v_add_u32 v10, s62, v12
    v_xor_b32 v12, 64, v10
    v_lshlrev_b32 v11, 4, v3
    v_lshl_add_u32 v11, v2, 10, v11
    s_lshl_b32 s62, s44, 7
    v_add_u32 v11, s62, v11
    s_waitcnt vmcnt(33)
    ds_read_b64_tr_b16 a[16:17], v236 offset:8192
    ds_read_b64_tr_b16 a[18:19], v236 offset:9216
    ds_read_b64_tr_b16 a[20:21], v237 offset:8192
    ds_read_b64_tr_b16 a[22:23], v237 offset:9216
    ds_read_b64_tr_b16 a[24:25], v236 offset:10240
    ds_read_b64_tr_b16 a[26:27], v236 offset:11264
    ds_read_b64_tr_b16 a[28:29], v237 offset:10240
    ds_read_b64_tr_b16 a[30:31], v237 offset:11264
    s_waitcnt vmcnt(29)
    ds_read_b64_tr_b16 a[32:33], v236 offset:28672
    ds_read_b64_tr_b16 a[34:35], v236 offset:29696
    ds_read_b64_tr_b16 a[36:37], v237 offset:28672
    ds_read_b64_tr_b16 a[38:39], v237 offset:29696
    ds_read_b64_tr_b16 a[40:41], v236 offset:30720
    ds_read_b64_tr_b16 a[42:43], v236 offset:31744
    ds_read_b64_tr_b16 a[44:45], v237 offset:30720
    ds_read_b64_tr_b16 a[46:47], v237 offset:31744
    s_waitcnt vmcnt(17)
    ds_read_b64_tr_b16 a[48:49], v236 offset:12288
    ds_read_b64_tr_b16 a[50:51], v236 offset:13312
    ds_read_b64_tr_b16 a[52:53], v237 offset:12288
    ds_read_b64_tr_b16 a[54:55], v237 offset:13312
    ds_read_b64_tr_b16 a[56:57], v236 offset:14336
    ds_read_b64_tr_b16 a[58:59], v236 offset:15360
    ds_read_b64_tr_b16 a[60:61], v237 offset:14336
    ds_read_b64_tr_b16 a[62:63], v237 offset:15360
    s_waitcnt vmcnt(13)
    ds_read_b64_tr_b16 a[64:65], v236 offset:0
    ds_read_b64_tr_b16 a[66:67], v236 offset:1024
    ds_read_b64_tr_b16 a[68:69], v237 offset:0
    ds_read_b64_tr_b16 a[70:71], v237 offset:1024
    ds_read_b64_tr_b16 a[72:73], v236 offset:2048
    ds_read_b64_tr_b16 a[74:75], v236 offset:3072
    ds_read_b64_tr_b16 a[76:77], v237 offset:2048
    ds_read_b64_tr_b16 a[78:79], v237 offset:3072
    s_waitcnt vmcnt(9)
    ds_read_b64_tr_b16 a[80:81], v236 offset:32768
    ds_read_b64_tr_b16 a[82:83], v236 offset:33792
    ds_read_b64_tr_b16 a[84:85], v237 offset:32768
    ds_read_b64_tr_b16 a[86:87], v237 offset:33792
    ds_read_b64_tr_b16 a[88:89], v236 offset:34816
    ds_read_b64_tr_b16 a[90:91], v236 offset:35840
    ds_read_b64_tr_b16 a[92:93], v237 offset:34816
    ds_read_b64_tr_b16 a[94:95], v237 offset:35840
    s_waitcnt vmcnt(8)
    v_cmp_ne_u32 vcc, v254, v5
    s_and_b32 s94, vcc_lo, 0xff
    s_cbranch_scc0 Lok_12
    s_mov_b32 s56, 32768
Lpoll_11:
    buffer_load_dword v5, v4, s[24:27], s89 offen sc1
    s_waitcnt vmcnt(0)
    v_cmp_ne_u32 vcc, v254, v5
    s_and_b32 s94, vcc_lo, 0xff
    s_cbranch_scc0 Lok_12
    s_sub_u32 s56, s56, 1
    s_cmp_lg_u32 s56, 0
    s_cbranch_scc1 Lpoll_11
Lok_12:
    s_nop 1
    buffer_load_dwordx4 v[128:131], v1, s[24:27], s58 offen offset:0
    buffer_load_dwordx4 v[132:135], v1, s[24:27], s59 offen offset:0
    buffer_load_dwordx4 v[136:139], v1, s[24:27], s60 offen offset:0
    buffer_load_dwordx4 v[140:143], v1, s[24:27], s61 offen offset:0
    buffer_load_dwordx4 v[144:147], v1, s[24:27], s58 offen offset:512
    buffer_load_dwordx4 v[148:151], v1, s[24:27], s59 offen offset:512
    buffer_load_dwordx4 v[152:155], v1, s[24:27], s60 offen offset:512
    buffer_load_dwordx4 v[156:159], v1, s[24:27], s61 offen offset:512
    s_waitcnt vmcnt(12)
    ds_read_b64_tr_b16 a[96:97], v236 offset:16384
    ds_read_b64_tr_b16 a[98:99], v236 offset:17408
    ds_read_b64_tr_b16 a[100:101], v237 offset:16384
    ds_read_b64_tr_b16 a[102:103], v237 offset:17408
    ds_read_b64_tr_b16 a[104:105], v236 offset:18432
    ds_read_b64_tr_b16 a[106:107], v236 offset:19456
    ds_read_b64_tr_b16 a[108:109], v237 offset:18432
    ds_read_b64_tr_b16 a[110:111], v237 offset:19456
    s_waitcnt vmcnt(8)
    ds_read_b64_tr_b16 a[112:113], v236 offset:20480
    ds_read_b64_tr_b16 a[114:115], v236 offset:21504
    ds_read_b64_tr_b16 a[116:117], v237 offset:20480
    ds_read_b64_tr_b16 a[118:119], v237 offset:21504
    ds_read_b64_tr_b16 a[120:121], v236 offset:22528
    ds_read_b64_tr_b16 a[122:123], v236 offset:23552
    ds_read_b64_tr_b16 a[124:125], v237 offset:22528
    ds_read_b64_tr_b16 a[126:127], v237 offset:23552
    s_waitcnt lgkmcnt(0)
    s_waitcnt vmcnt(6)
    v_swap_b32 v130, v132
    v_swap_b32 v131, v133
    s_nop 1
    v_mfma_f32_32x32x16_bf16 v[64:79], v[128:131], v[176:179], v[64:79]
    v_mfma_f32_32x32x16_bf16 v[80:95], v[132:135], v[176:179], v[80:95]
    s_waitcnt vmcnt(4)
    v_swap_b32 v138, v140
    v_swap_b32 v139, v141
    s_nop 1
    v_mfma_f32_32x32x16_bf16 v[64:79], v[136:139], v[176:179], v[64:79]
    v_mfma_f32_32x32x16_bf16 v[80:95], v[140:143], v[176:179], v[80:95]
    s_nop 10
    v_exp_f32 v64, v64
    v_exp_f32 v65, v65
    v_exp_f32 v66, v66
    s_add_u32 m0, s54, 24576
    s_mov_b32 s57, 65536
    buffer_load_dwordx4 v232, s[20:23], s57 offen offset:0 lds
    v_exp_f32 v67, v67
    v_add_f32 v64, 1.0, v64
    v_add_f32 v65, 1.0, v65
    v_add_f32 v66, 1.0, v66
    buffer_load_dwordx4 v233, s[20:23], s57 offen offset:1024 lds
    v_add_f32 v67, 1.0, v67
    v_rcp_f32 v64, v64
    v_rcp_f32 v65, v65
    v_rcp_f32 v66, v66
    v_rcp_f32 v67, v67
    buffer_load_dwordx4 v234, s[20:23], s57 offen offset:2048 lds
    v_fma_f32 v64, v64, -2.0, 1.0
    v_fma_f32 v65, v65, -2.0, 1.0
    v_fma_f32 v66, v66, -2.0, 1.0
    v_fma_f32 v67, v67, -2.0, 1.0
    buffer_load_dwordx4 v235, s[20:23], s57 offen offset:3072 lds
    v_cvt_pk_bf16_f32 v160, v64, v65
    v_cvt_pk_bf16_f32 v161, v66, v67
    v_exp_f32 v68, v68
    v_exp_f32 v69, v69
    v_exp_f32 v70, v70
    s_add_u32 m0, s54, 36864
    s_mov_b32 s57, 98304
    buffer_load_dwordx4 v232, s[20:23], s57 offen offset:0 lds
    v_exp_f32 v71, v71
    v_add_f32 v68, 1.0, v68
    v_add_f32 v69, 1.0, v69
    v_add_f32 v70, 1.0, v70
    buffer_load_dwordx4 v233, s[20:23], s57 offen offset:1024 lds
    v_add_f32 v71, 1.0, v71
    v_rcp_f32 v68, v68
    v_rcp_f32 v69, v69
    v_rcp_f32 v70, v70
    v_rcp_f32 v71, v71
    buffer_load_dwordx4 v234, s[20:23], s57 offen offset:2048 lds
    v_fma_f32 v68, v68, -2.0, 1.0
    v_fma_f32 v69, v69, -2.0, 1.0
    v_fma_f32 v70, v70, -2.0, 1.0
    v_fma_f32 v71, v71, -2.0, 1.0
    buffer_load_dwordx4 v235, s[20:23], s57 offen offset:3072 lds
    v_cvt_pk_bf16_f32 v162, v68, v69
    v_cvt_pk_bf16_f32 v163, v70, v71
    s_waitcnt vmcnt(10)
    v_swap_b32 v146, v148
    v_swap_b32 v147, v149
    s_nop 1
    v_mfma_f32_32x32x16_bf16 v[96:111], v[144:147], v[176:179], v[96:111]
    v_mfma_f32_32x32x16_bf16 v[112:127], v[148:151], v[176:179], v[112:127]
    s_waitcnt vmcnt(8)
    v_swap_b32 v154, v156
    v_swap_b32 v155, v157
    s_nop 1
    v_mfma_f32_32x32x16_bf16 v[96:111], v[152:155], v[176:179], v[96:111]
    v_mfma_f32_32x32x16_bf16 v[112:127], v[156:159], v[176:179], v[112:127]
    v_exp_f32 v72, v72
    v_exp_f32 v73, v73
    v_exp_f32 v74, v74
    v_exp_f32 v75, v75
    s_add_u32 m0, s54, 8192
    s_mov_b32 s57, 196608
    buffer_load_dwordx4 v232, s[20:23], s57 offen offset:0 lds
    v_add_f32 v72, 1.0, v72
    v_add_f32 v73, 1.0, v73
    v_add_f32 v74, 1.0, v74
    v_add_f32 v75, 1.0, v75
    v_rcp_f32 v72, v72
    v_rcp_f32 v73, v73
    buffer_load_dwordx4 v233, s[20:23], s57 offen offset:1024 lds
    v_rcp_f32 v74, v74
    v_rcp_f32 v75, v75
    v_fma_f32 v72, v72, -2.0, 1.0
    v_fma_f32 v73, v73, -2.0, 1.0
    v_fma_f32 v74, v74, -2.0, 1.0
    v_fma_f32 v75, v75, -2.0, 1.0
    buffer_load_dwordx4 v234, s[20:23], s57 offen offset:2048 lds
    v_cvt_pk_bf16_f32 v164, v72, v73
    v_cvt_pk_bf16_f32 v165, v74, v75
    v_exp_f32 v76, v76
    v_exp_f32 v77, v77
    v_exp_f32 v78, v78
    v_exp_f32 v79, v79
    buffer_load_dwordx4 v235, s[20:23], s57 offen offset:3072 lds
    v_add_f32 v76, 1.0, v76
    v_add_f32 v77, 1.0, v77
    v_add_f32 v78, 1.0, v78
    v_add_f32 v79, 1.0, v79
    v_rcp_f32 v76, v76
    v_rcp_f32 v77, v77
    s_add_u32 m0, s54, 28672
    s_mov_b32 s57, 229376
    buffer_load_dwordx4 v232, s[20:23], s57 offen offset:0 lds
    v_rcp_f32 v78, v78
    v_rcp_f32 v79, v79
    v_fma_f32 v76, v76, -2.0, 1.0
    v_fma_f32 v77, v77, -2.0, 1.0
    v_fma_f32 v78, v78, -2.0, 1.0
    v_fma_f32 v79, v79, -2.0, 1.0
    buffer_load_dwordx4 v233, s[20:23], s57 offen offset:1024 lds
    v_cvt_pk_bf16_f32 v166, v76, v77
    v_cvt_pk_bf16_f32 v167, v78, v79
    s_waitcnt vmcnt(10)
    ds_read_b64_tr_b16 a[128:129], v236 offset:24576
    ds_read_b64_tr_b16 a[130:131], v236 offset:25600
    ds_read_b64_tr_b16 a[132:133], v237 offset:24576
    ds_read_b64_tr_b16 a[134:135], v237 offset:25600
    ds_read_b64_tr_b16 a[136:137], v236 offset:26624
    ds_read_b64_tr_b16 a[138:139], v236 offset:27648
    ds_read_b64_tr_b16 a[140:141], v237 offset:26624
    ds_read_b64_tr_b16 a[142:143], v237 offset:27648
    ds_write_b128 v6, v[160:163] offset:0
    ds_write_b128 v6, v[164:167] offset:1024
    v_exp_f32 v80, v80
    v_exp_f32 v81, v81
    v_exp_f32 v82, v82
    v_exp_f32 v83, v83
    buffer_load_dwordx4 v234, s[20:23], s57 offen offset:2048 lds
    v_add_f32 v80, 1.0, v80
    v_add_f32 v81, 1.0, v81
    v_add_f32 v82, 1.0, v82
    v_add_f32 v83, 1.0, v83
    v_rcp_f32 v80, v80
    v_rcp_f32 v81, v81
    buffer_load_dwordx4 v235, s[20:23], s57 offen offset:3072 lds
    v_rcp_f32 v82, v82
    v_rcp_f32 v83, v83
    v_fma_f32 v80, v80, -2.0, 1.0
    v_fma_f32 v81, v81, -2.0, 1.0
    v_fma_f32 v82, v82, -2.0, 1.0
    v_fma_f32 v83, v83, -2.0, 1.0
    s_add_u32 m0, s54, 12288
    s_mov_b32 s57, 327680
    buffer_load_dwordx4 v232, s[20:23], s57 offen offset:0 lds
    v_cvt_pk_bf16_f32 v168, v80, v81
    v_cvt_pk_bf16_f32 v169, v82, v83
    s_waitcnt vmcnt(9)
    ds_read_b64_tr_b16 a[144:145], v236 offset:36864
    ds_read_b64_tr_b16 a[146:147], v236 offset:37888
    ds_read_b64_tr_b16 a[148:149], v237 offset:36864
    ds_read_b64_tr_b16 a[150:151], v237 offset:37888
    ds_read_b64_tr_b16 a[152:153], v236 offset:38912
    ds_read_b64_tr_b16 a[154:155], v236 offset:39936
    ds_read_b64_tr_b16 a[156:157], v237 offset:38912
    ds_read_b64_tr_b16 a[158:159], v237 offset:39936
    s_waitcnt lgkmcnt(8)
    s_barrier
    ds_read_b128 v[128:131], v7 offset:0
    ds_read_b128 v[132:135], v7 offset:1024
    ds_read_b128 v[136:139], v7 offset:40960
    ds_read_b128 v[140:143], v7 offset:41984
    ds_read_b128 v[144:147], v8 offset:0
    ds_read_b128 v[148:151], v8 offset:1024
    ds_read_b128 v[152:155], v8 offset:40960
    ds_read_b128 v[156:159], v8 offset:41984
    v_exp_f32 v84, v84
    v_exp_f32 v85, v85
    v_exp_f32 v86, v86
    v_exp_f32 v87, v87
    buffer_load_dwordx4 v233, s[20:23], s57 offen offset:1024 lds
    v_add_f32 v84, 1.0, v84
    v_add_f32 v85, 1.0, v85
    v_add_f32 v86, 1.0, v86
    v_add_f32 v87, 1.0, v87
    v_rcp_f32 v84, v84
    v_rcp_f32 v85, v85
    buffer_load_dwordx4 v234, s[20:23], s57 offen offset:2048 lds
    v_rcp_f32 v86, v86
    v_rcp_f32 v87, v87
    v_fma_f32 v84, v84, -2.0, 1.0
    v_fma_f32 v85, v85, -2.0, 1.0
    s_waitcnt lgkmcnt(7)
    v_mfma_f32_32x32x16_bf16 v[184:199], a[0:3], v[128:131], 0
    v_fma_f32 v86, v86, -2.0, 1.0
    v_fma_f32 v87, v87, -2.0, 1.0
    buffer_load_dwordx4 v235, s[20:23], s57 offen offset:3072 lds
    v_cvt_pk_bf16_f32 v170, v84, v85
    v_cvt_pk_bf16_f32 v171, v86, v87
    v_mfma_f32_32x32x16_bf16 v[200:215], a[4:7], v[128:131], 0
    s_waitcnt vmcnt(8)
    ds_read_b64_tr_b16 a[160:161], v236 offset:8192
    ds_read_b64_tr_b16 a[162:163], v236 offset:9216
    ds_read_b64_tr_b16 a[164:165], v237 offset:8192
    ds_read_b64_tr_b16 a[166:167], v237 offset:9216
    ds_read_b64_tr_b16 a[168:169], v236 offset:10240
    ds_read_b64_tr_b16 a[170:171], v236 offset:11264
    ds_read_b64_tr_b16 a[172:173], v237 offset:10240
    ds_read_b64_tr_b16 a[174:175], v237 offset:11264
    v_exp_f32 v88, v88
    v_exp_f32 v89, v89
    v_exp_f32 v90, v90
    v_exp_f32 v91, v91
    s_add_u32 m0, s54, 32768
    s_mov_b32 s57, 360448
    buffer_load_dwordx4 v232, s[20:23], s57 offen offset:0 lds
    s_waitcnt lgkmcnt(14)
    v_mfma_f32_32x32x16_bf16 v[184:199], a[16:19], v[132:135], v[184:199]
    v_add_f32 v88, 1.0, v88
    v_add_f32 v89, 1.0, v89
    v_add_f32 v90, 1.0, v90
    v_add_f32 v91, 1.0, v91
    v_mfma_f32_32x32x16_bf16 v[200:215], a[20:23], v[132:135], v[200:215]
    v_rcp_f32 v88, v88
    v_rcp_f32 v89, v89
    buffer_load_dwordx4 v233, s[20:23], s57 offen offset:1024 lds
    v_rcp_f32 v90, v90
    s_waitcnt lgkmcnt(13)
    v_mfma_f32_32x32x16_bf16 v[184:199], a[32:35], v[136:139], v[184:199]
    v_rcp_f32 v91, v91
    v_fma_f32 v88, v88, -2.0, 1.0
    v_fma_f32 v89, v89, -2.0, 1.0
    v_fma_f32 v90, v90, -2.0, 1.0
    v_mfma_f32_32x32x16_bf16 v[200:215], a[36:39], v[136:139], v[200:215]
    v_fma_f32 v91, v91, -2.0, 1.0
    buffer_load_dwordx4 v234, s[20:23], s57 offen offset:2048 lds
    v_cvt_pk_bf16_f32 v172, v88, v89
    v_cvt_pk_bf16_f32 v173, v90, v91
    s_waitcnt lgkmcnt(12)
    v_mfma_f32_32x32x16_bf16 v[184:199], a[48:51], v[140:143], v[184:199]
    s_waitcnt vmcnt(7)
    ds_read_b64_tr_b16 a[176:177], v236 offset:28672
    ds_read_b64_tr_b16 a[178:179], v236 offset:29696
    ds_read_b64_tr_b16 a[180:181], v237 offset:28672
    ds_read_b64_tr_b16 a[182:183], v237 offset:29696
    ds_read_b64_tr_b16 a[184:185], v236 offset:30720
    ds_read_b64_tr_b16 a[186:187], v236 offset:31744
    ds_read_b64_tr_b16 a[188:189], v237 offset:30720
    ds_read_b64_tr_b16 a[190:191], v237 offset:31744
    v_exp_f32 v92, v92
    v_exp_f32 v93, v93
    v_exp_f32 v94, v94
    v_exp_f32 v95, v95
    buffer_load_dwordx4 v235, s[20:23], s57 offen offset:3072 lds
    v_mfma_f32_32x32x16_bf16 v[200:215], a[52:55], v[140:143], v[200:215]
    v_add_f32 v92, 1.0, v92
    v_add_f32 v93, 1.0, v93
    v_add_f32 v94, 1.0, v94
    v_add_f32 v95, 1.0, v95
    s_waitcnt lgkmcnt(15)
    v_mfma_f32_32x32x16_bf16 v[184:199], a[64:67], v[144:147], v[184:199]
    v_rcp_f32 v92, v92
    v_rcp_f32 v93, v93
    s_add_u32 m0, s54, 16384
    s_mov_b32 s57, 458752
    buffer_load_dwordx4 v232, s[20:23], s57 offen offset:0 lds
    v_rcp_f32 v94, v94
    v_mfma_f32_32x32x16_bf16 v[200:215], a[68:71], v[144:147], v[200:215]
    v_rcp_f32 v95, v95
    v_fma_f32 v92, v92, -2.0, 1.0
    v_fma_f32 v93, v93, -2.0, 1.0
    v_fma_f32 v94, v94, -2.0, 1.0
    s_waitcnt lgkmcnt(15)
    v_mfma_f32_32x32x16_bf16 v[184:199], a[80:83], v[148:151], v[184:199]
    v_fma_f32 v95, v95, -2.0, 1.0
    buffer_load_dwordx4 v233, s[20:23], s57 offen offset:1024 lds
    v_cvt_pk_bf16_f32 v174, v92, v93
    v_cvt_pk_bf16_f32 v175, v94, v95
    v_mfma_f32_32x32x16_bf16 v[200:215], a[84:87], v[148:151], v[200:215]
    s_waitcnt vmcnt(6)
    ds_read_b64_tr_b16 a[192:193], v236 offset:12288
    ds_read_b64_tr_b16 a[194:195], v236 offset:13312
    ds_read_b64_tr_b16 a[196:197], v237 offset:12288
    ds_read_b64_tr_b16 a[198:199], v237 offset:13312
    ds_read_b64_tr_b16 a[200:201], v236 offset:14336
    ds_read_b64_tr_b16 a[202:203], v236 offset:15360
    ds_read_b64_tr_b16 a[204:205], v237 offset:14336
    ds_read_b64_tr_b16 a[206:207], v237 offset:15360
    ds_write_b128 v6, v[168:171] offset:2048
    ds_write_b128 v6, v[172:175] offset:3072
    v_exp_f32 v96, v96
    v_exp_f32 v97, v97
    v_exp_f32 v98, v98
    v_exp_f32 v99, v99
    buffer_load_dwordx4 v234, s[20:23], s57 offen offset:2048 lds
    v_add_f32 v96, 1.0, v96
    s_waitcnt lgkmcnt(15)
    v_mfma_f32_32x32x16_bf16 v[184:199], a[96:99], v[152:155], v[184:199]
    v_add_f32 v97, 1.0, v97
    v_add_f32 v98, 1.0, v98
    v_add_f32 v99, 1.0, v99
    v_rcp_f32 v96, v96
    v_mfma_f32_32x32x16_bf16 v[200:215], a[100:103], v[152:155], v[200:215]
    v_rcp_f32 v97, v97
    buffer_load_dwordx4 v235, s[20:23], s57 offen offset:3072 lds
    v_rcp_f32 v98, v98
    v_rcp_f32 v99, v99
    v_fma_f32 v96, v96, -2.0, 1.0
    v_fma_f32 v97, v97, -2.0, 1.0
    s_waitcnt lgkmcnt(15)
    v_mfma_f32_32x32x16_bf16 v[184:199], a[112:115], v[156:159], v[184:199]
    v_fma_f32 v98, v98, -2.0, 1.0
    v_fma_f32 v99, v99, -2.0, 1.0
    s_add_u32 m0, s54, 20480
    s_mov_b32 s57, 491520
    buffer_load_dwordx4 v232, s[20:23], s57 offen offset:0 lds
    v_cvt_pk_bf16_f32 v160, v96, v97
    v_cvt_pk_bf16_f32 v161, v98, v99
    v_mfma_f32_32x32x16_bf16 v[200:215], a[116:119], v[156:159], v[200:215]
    s_waitcnt vmcnt(5)
    ds_read_b64_tr_b16 a[208:209], v236 offset:32768
    ds_read_b64_tr_b16 a[210:211], v236 offset:33792
    ds_read_b64_tr_b16 a[212:213], v237 offset:32768
    ds_read_b64_tr_b16 a[214:215], v237 offset:33792
    ds_read_b64_tr_b16 a[216:217], v236 offset:34816
    ds_read_b64_tr_b16 a[218:219], v236 offset:35840
    ds_read_b64_tr_b16 a[220:221], v237 offset:34816
    ds_read_b64_tr_b16 a[222:223], v237 offset:35840
    s_waitcnt lgkmcnt(8)
    s_barrier
    ds_read_b128 v[16:19], v7 offset:2048
    ds_read_b128 v[20:23], v7 offset:3072
    ds_read_b128 v[24:27], v7 offset:43008
    ds_read_b128 v[28:31], v7 offset:44032
    ds_read_b128 v[32:35], v8 offset:2048
    ds_read_b128 v[36:39], v8 offset:3072
    ds_read_b128 v[40:43], v8 offset:43008
    ds_read_b128 v[44:47], v8 offset:44032
    v_exp_f32 v100, v100
    v_exp_f32 v101, v101
    v_exp_f32 v102, v102
    v_exp_f32 v103, v103
    buffer_load_dwordx4 v233, s[20:23], s57 offen offset:1024 lds
    v_add_f32 v100, 1.0, v100
    v_add_f32 v101, 1.0, v101
    v_add_f32 v102, 1.0, v102
    v_add_f32 v103, 1.0, v103
    v_rcp_f32 v100, v100
    v_rcp_f32 v101, v101
    buffer_load_dwordx4 v234, s[20:23], s57 offen offset:2048 lds
    v_rcp_f32 v102, v102
    v_rcp_f32 v103, v103
    v_fma_f32 v100, v100, -2.0, 1.0
    v_fma_f32 v101, v101, -2.0, 1.0
    s_waitcnt lgkmcnt(7)
    v_mfma_f32_32x32x16_bf16 v[184:199], a[8:11], v[16:19], v[184:199]
    v_fma_f32 v102, v102, -2.0, 1.0
    v_fma_f32 v103, v103, -2.0, 1.0
    buffer_load_dwordx4 v235, s[20:23], s57 offen offset:3072 lds
    v_cvt_pk_bf16_f32 v162, v100, v101
    v_cvt_pk_bf16_f32 v163, v102, v103
    v_mfma_f32_32x32x16_bf16 v[200:215], a[12:15], v[16:19], v[200:215]
    s_waitcnt vmcnt(4)
    ds_read_b64_tr_b16 a[224:225], v236 offset:16384
    ds_read_b64_tr_b16 a[226:227], v236 offset:17408
    ds_read_b64_tr_b16 a[228:229], v237 offset:16384
    ds_read_b64_tr_b16 a[230:231], v237 offset:17408
    ds_read_b64_tr_b16 a[232:233], v236 offset:18432
    ds_read_b64_tr_b16 a[234:235], v236 offset:19456
    ds_read_b64_tr_b16 a[236:237], v237 offset:18432
    ds_read_b64_tr_b16 a[238:239], v237 offset:19456
    v_exp_f32 v104, v104
    v_exp_f32 v105, v105
    v_exp_f32 v106, v106
    v_exp_f32 v107, v107
    s_waitcnt lgkmcnt(14)
    v_mfma_f32_32x32x16_bf16 v[184:199], a[24:27], v[20:23], v[184:199]
    v_add_f32 v104, 1.0, v104
    v_add_f32 v105, 1.0, v105
    v_add_f32 v106, 1.0, v106
    v_add_f32 v107, 1.0, v107
    v_mfma_f32_32x32x16_bf16 v[200:215], a[28:31], v[20:23], v[200:215]
    v_rcp_f32 v104, v104
    v_rcp_f32 v105, v105
    v_rcp_f32 v106, v106
    s_waitcnt lgkmcnt(13)
    v_mfma_f32_32x32x16_bf16 v[184:199], a[40:43], v[24:27], v[184:199]
    v_rcp_f32 v107, v107
    v_fma_f32 v104, v104, -2.0, 1.0
    v_fma_f32 v105, v105, -2.0, 1.0
    v_fma_f32 v106, v106, -2.0, 1.0
    v_mfma_f32_32x32x16_bf16 v[200:215], a[44:47], v[24:27], v[200:215]
    v_fma_f32 v107, v107, -2.0, 1.0
    v_cvt_pk_bf16_f32 v164, v104, v105
    v_cvt_pk_bf16_f32 v165, v106, v107
    s_waitcnt lgkmcnt(12)
    v_mfma_f32_32x32x16_bf16 v[184:199], a[56:59], v[28:31], v[184:199]
    s_waitcnt vmcnt(0)
    ds_read_b64_tr_b16 a[240:241], v236 offset:20480
    ds_read_b64_tr_b16 a[242:243], v236 offset:21504
    ds_read_b64_tr_b16 a[244:245], v237 offset:20480
    ds_read_b64_tr_b16 a[246:247], v237 offset:21504
    ds_read_b64_tr_b16 a[248:249], v236 offset:22528
    ds_read_b64_tr_b16 a[250:251], v236 offset:23552
    ds_read_b64_tr_b16 a[252:253], v237 offset:22528
    ds_read_b64_tr_b16 a[254:255], v237 offset:23552
    v_exp_f32 v108, v108
    v_exp_f32 v109, v109
    v_exp_f32 v110, v110
    v_exp_f32 v111, v111
    v_mfma_f32_32x32x16_bf16 v[200:215], a[60:63], v[28:31], v[200:215]
    v_add_f32 v108, 1.0, v108
    v_add_f32 v109, 1.0, v109
    v_add_f32 v110, 1.0, v110
    v_add_f32 v111, 1.0, v111
    s_waitcnt lgkmcnt(15)
    v_mfma_f32_32x32x16_bf16 v[184:199], a[72:75], v[32:35], v[184:199]
    v_rcp_f32 v108, v108
    v_rcp_f32 v109, v109
    v_rcp_f32 v110, v110
    v_mfma_f32_32x32x16_bf16 v[200:215], a[76:79], v[32:35], v[200:215]
    v_rcp_f32 v111, v111
    v_fma_f32 v108, v108, -2.0, 1.0
    v_fma_f32 v109, v109, -2.0, 1.0
    v_fma_f32 v110, v110, -2.0, 1.0
    s_waitcnt lgkmcnt(15)
    v_mfma_f32_32x32x16_bf16 v[184:199], a[88:91], v[36:39], v[184:199]
    v_fma_f32 v111, v111, -2.0, 1.0
    v_cvt_pk_bf16_f32 v166, v108, v109
    v_cvt_pk_bf16_f32 v167, v110, v111
    v_mfma_f32_32x32x16_bf16 v[200:215], a[92:95], v[36:39], v[200:215]
    ds_write_b128 v6, v[160:163] offset:4096
    ds_write_b128 v6, v[164:167] offset:5120
    v_exp_f32 v112, v112
    v_exp_f32 v113, v113
    v_exp_f32 v114, v114
    v_exp_f32 v115, v115
    v_add_f32 v112, 1.0, v112
    s_waitcnt lgkmcnt(15)
    v_mfma_f32_32x32x16_bf16 v[184:199], a[104:107], v[40:43], v[184:199]
    v_add_f32 v113, 1.0, v113
    v_add_f32 v114, 1.0, v114
    v_add_f32 v115, 1.0, v115
    v_rcp_f32 v112, v112
    v_mfma_f32_32x32x16_bf16 v[200:215], a[108:111], v[40:43], v[200:215]
    v_rcp_f32 v113, v113
    v_rcp_f32 v114, v114
    v_rcp_f32 v115, v115
    v_fma_f32 v112, v112, -2.0, 1.0
    v_fma_f32 v113, v113, -2.0, 1.0
    s_waitcnt lgkmcnt(15)
    v_mfma_f32_32x32x16_bf16 v[184:199], a[120:123], v[44:47], v[184:199]
    v_fma_f32 v114, v114, -2.0, 1.0
    v_fma_f32 v115, v115, -2.0, 1.0
    v_cvt_pk_bf16_f32 v168, v112, v113
    v_cvt_pk_bf16_f32 v169, v114, v115
    v_mfma_f32_32x32x16_bf16 v[200:215], a[124:127], v[44:47], v[200:215]
    s_waitcnt lgkmcnt(2)
    s_waitcnt lgkmcnt(0)
    s_barrier
    ds_read_b128 v[128:131], v7 offset:4096
    ds_read_b128 v[132:135], v7 offset:5120
    ds_read_b128 v[136:139], v7 offset:45056
    ds_read_b128 v[140:143], v7 offset:46080
    ds_read_b128 v[144:147], v8 offset:4096
    ds_read_b128 v[148:151], v8 offset:5120
    ds_read_b128 v[152:155], v8 offset:45056
    ds_read_b128 v[156:159], v8 offset:46080
    v_exp_f32 v116, v116
    v_exp_f32 v117, v117
    v_exp_f32 v118, v118
    v_exp_f32 v119, v119
    v_add_f32 v116, 1.0, v116
    v_add_f32 v117, 1.0, v117
    v_add_f32 v118, 1.0, v118
    v_add_f32 v119, 1.0, v119
    v_rcp_f32 v116, v116
    v_rcp_f32 v117, v117
    v_rcp_f32 v118, v118
    v_rcp_f32 v119, v119
    v_fma_f32 v116, v116, -2.0, 1.0
    v_fma_f32 v117, v117, -2.0, 1.0
    s_waitcnt lgkmcnt(7)
    v_mfma_f32_32x32x16_bf16 v[184:199], a[128:131], v[128:131], v[184:199]
    v_fma_f32 v118, v118, -2.0, 1.0
    v_fma_f32 v119, v119, -2.0, 1.0
    v_cvt_pk_bf16_f32 v170, v116, v117
    v_cvt_pk_bf16_f32 v171, v118, v119
    v_mfma_f32_32x32x16_bf16 v[200:215], a[132:135], v[128:131], v[200:215]
    v_exp_f32 v120, v120
    v_exp_f32 v121, v121
    v_exp_f32 v122, v122
    v_exp_f32 v123, v123
    s_waitcnt lgkmcnt(6)
    v_mfma_f32_32x32x16_bf16 v[184:199], a[144:147], v[132:135], v[184:199]
    v_add_f32 v120, 1.0, v120
    v_add_f32 v121, 1.0, v121
    v_add_f32 v122, 1.0, v122
    v_add_f32 v123, 1.0, v123
    v_mfma_f32_32x32x16_bf16 v[200:215], a[148:151], v[132:135], v[200:215]
    v_rcp_f32 v120, v120
    v_rcp_f32 v121, v121
    v_rcp_f32 v122, v122
    s_waitcnt lgkmcnt(5)
    v_mfma_f32_32x32x16_bf16 v[184:199], a[160:163], v[136:139], v[184:199]
    v_rcp_f32 v123, v123
    v_fma_f32 v120, v120, -2.0, 1.0
    v_fma_f32 v121, v121, -2.0, 1.0
    v_fma_f32 v122, v122, -2.0, 1.0
    v_mfma_f32_32x32x16_bf16 v[200:215], a[164:167], v[136:139], v[200:215]
    v_fma_f32 v123, v123, -2.0, 1.0
    v_cvt_pk_bf16_f32 v172, v120, v121
    v_cvt_pk_bf16_f32 v173, v122, v123
    s_waitcnt lgkmcnt(4)
    v_mfma_f32_32x32x16_bf16 v[184:199], a[176:179], v[140:143], v[184:199]
    v_exp_f32 v124, v124
    v_exp_f32 v125, v125
    v_exp_f32 v126, v126
    v_exp_f32 v127, v127
    v_mfma_f32_32x32x16_bf16 v[200:215], a[180:183], v[140:143], v[200:215]
    v_add_f32 v124, 1.0, v124
    v_add_f32 v125, 1.0, v125
    v_add_f32 v126, 1.0, v126
    v_add_f32 v127, 1.0, v127
    s_waitcnt lgkmcnt(3)
    v_mfma_f32_32x32x16_bf16 v[184:199], a[192:195], v[144:147], v[184:199]
    v_rcp_f32 v124, v124
    v_rcp_f32 v125, v125
    v_rcp_f32 v126, v126
    v_mfma_f32_32x32x16_bf16 v[200:215], a[196:199], v[144:147], v[200:215]
    v_rcp_f32 v127, v127
    v_fma_f32 v124, v124, -2.0, 1.0
    v_fma_f32 v125, v125, -2.0, 1.0
    v_fma_f32 v126, v126, -2.0, 1.0
    s_waitcnt lgkmcnt(2)
    v_mfma_f32_32x32x16_bf16 v[184:199], a[208:211], v[148:151], v[184:199]
    v_fma_f32 v127, v127, -2.0, 1.0
    v_cvt_pk_bf16_f32 v174, v124, v125
    v_cvt_pk_bf16_f32 v175, v126, v127
    v_mfma_f32_32x32x16_bf16 v[200:215], a[212:215], v[148:151], v[200:215]
    ds_write_b128 v6, v[168:171] offset:6144
    ds_write_b128 v6, v[172:175] offset:7168
    s_waitcnt lgkmcnt(3)
    v_mfma_f32_32x32x16_bf16 v[184:199], a[224:227], v[152:155], v[184:199]
    v_mfma_f32_32x32x16_bf16 v[200:215], a[228:231], v[152:155], v[200:215]
    s_waitcnt lgkmcnt(2)
    v_mfma_f32_32x32x16_bf16 v[184:199], a[240:243], v[156:159], v[184:199]
    v_mfma_f32_32x32x16_bf16 v[200:215], a[244:247], v[156:159], v[200:215]
    s_waitcnt lgkmcnt(0)
    s_barrier
    ds_read_b128 v[16:19], v7 offset:6144
    ds_read_b128 v[20:23], v7 offset:7168
    ds_read_b128 v[24:27], v7 offset:47104
    ds_read_b128 v[28:31], v7 offset:48128
    ds_read_b128 v[32:35], v8 offset:6144
    ds_read_b128 v[36:39], v8 offset:7168
    ds_read_b128 v[40:43], v8 offset:47104
    ds_read_b128 v[44:47], v8 offset:48128
    s_waitcnt lgkmcnt(7)
    v_mfma_f32_32x32x16_bf16 v[184:199], a[136:139], v[16:19], v[184:199]
    s_waitcnt lgkmcnt(6)
    v_mfma_f32_32x32x16_bf16 v[184:199], a[152:155], v[20:23], v[184:199]
    s_waitcnt lgkmcnt(5)
    v_mfma_f32_32x32x16_bf16 v[184:199], a[168:171], v[24:27], v[184:199]
    s_waitcnt lgkmcnt(4)
    v_mfma_f32_32x32x16_bf16 v[184:199], a[184:187], v[28:31], v[184:199]
    s_waitcnt lgkmcnt(3)
    v_mfma_f32_32x32x16_bf16 v[184:199], a[200:203], v[32:35], v[184:199]
    s_waitcnt lgkmcnt(2)
    v_mfma_f32_32x32x16_bf16 v[184:199], a[216:219], v[36:39], v[184:199]
    s_waitcnt lgkmcnt(1)
    v_mfma_f32_32x32x16_bf16 v[184:199], a[232:235], v[40:43], v[184:199]
    s_waitcnt lgkmcnt(0)
    v_mfma_f32_32x32x16_bf16 v[184:199], a[248:251], v[44:47], v[184:199]
    v_mfma_f32_32x32x16_bf16 v[200:215], a[140:143], v[16:19], v[200:215]
    s_nop 10
    v_cvt_pk_bf16_f32 v64, v184, v185
    v_cvt_pk_bf16_f32 v65, v186, v187
    ds_write_b64 v216, v[64:65]
    v_mfma_f32_32x32x16_bf16 v[200:215], a[156:159], v[20:23], v[200:215]
    v_cvt_pk_bf16_f32 v66, v188, v189
    v_cvt_pk_bf16_f32 v67, v190, v191
    ds_write_b64 v217, v[66:67]
    v_mfma_f32_32x32x16_bf16 v[200:215], a[172:175], v[24:27], v[200:215]
    v_cvt_pk_bf16_f32 v68, v192, v193
    v_cvt_pk_bf16_f32 v69, v194, v195
    ds_write_b64 v218, v[68:69]
    v_mfma_f32_32x32x16_bf16 v[200:215], a[188:191], v[28:31], v[200:215]
    v_cvt_pk_bf16_f32 v70, v196, v197
    v_cvt_pk_bf16_f32 v71, v198, v199
    ds_write_b64 v219, v[70:71]
    v_mfma_f32_32x32x16_bf16 v[200:215], a[204:207], v[32:35], v[200:215]
    ds_read_b128 v[96:99], v10 offset:0
    ds_read_b128 v[100:103], v10 offset:2048
    s_lshl_b32 s58, s53, 15
    s_lshl_b32 s59, s52, 9
    s_add_u32 s58, s58, s59
    s_add_u32 s59, s58, 16384
    v_mfma_f32_32x32x16_bf16 v[200:215], a[220:223], v[36:39], v[200:215]
    v_mfma_f32_32x32x16_bf16 v[200:215], a[236:239], v[40:43], v[200:215]
    v_mfma_f32_32x32x16_bf16 v[200:215], a[252:255], v[44:47], v[200:215]
    s_waitcnt lgkmcnt(1)
    buffer_store_dwordx4 v[96:99], v11, s[28:31], s58 offen
    s_waitcnt lgkmcnt(0)
    buffer_store_dwordx4 v[100:103], v11, s[28:31], s59 offen
    s_nop 7
    v_cvt_pk_bf16_f32 v72, v200, v201
    v_cvt_pk_bf16_f32 v73, v202, v203
    ds_write_b64 v220, v[72:73]
    v_cvt_pk_bf16_f32 v74, v204, v205
    v_cvt_pk_bf16_f32 v75, v206, v207
    ds_write_b64 v221, v[74:75]
    v_cvt_pk_bf16_f32 v76, v208, v209
    v_cvt_pk_bf16_f32 v77, v210, v211
    ds_write_b64 v222, v[76:77]
    v_cvt_pk_bf16_f32 v78, v212, v213
    v_cvt_pk_bf16_f32 v79, v214, v215
    ds_write_b64 v223, v[78:79]
    ds_read_b128 v[104:107], v12 offset:0
    ds_read_b128 v[108:111], v12 offset:2048
    s_waitcnt lgkmcnt(1)
    buffer_store_dwordx4 v[104:107], v11, s[28:31], s58 offen offset:64
    s_waitcnt lgkmcnt(0)
    buffer_store_dwordx4 v[108:111], v11, s[28:31], s59 offen offset:64
Lexit:
    s_endpgm
Lcode_end:
.section .rodata,"a"
.p2align 6
.amdhsa_kernel standalone__seq2seq_rnn_t_joint__speech_kernel
  .amdhsa_next_free_vgpr 512
  .amdhsa_next_free_sgpr 102
  .amdhsa_accum_offset 256
  .amdhsa_group_segment_fixed_size 0
  .amdhsa_kernarg_size 80
  .amdhsa_user_sgpr_count 2
  .amdhsa_user_sgpr_kernarg_segment_ptr 1
  .amdhsa_system_sgpr_workgroup_id_x 1
  .amdhsa_float_denorm_mode_32 3
.end_amdhsa_kernel
```
